```python
import torch

def _softmax(x, axis=-1):
    return torch.softmax(x, dim=axis)
def _gelu(x):
    return torch.nn.functional.gelu(x, approximate="tanh")
def _silu(x):
    return torch.nn.functional.silu(x)
def _sigmoid(x):
    return torch.sigmoid(x)
def _layernorm(x, axis=-1, eps=1e-5):
    m = x.mean(dim=axis, keepdim=True)
    v = x.var(dim=axis, keepdim=True, unbiased=False)
    return (x - m) / torch.sqrt(v + eps)
def _scatter_add(tgt, idx, src, axis=0):
    return tgt.clone().index_add_(axis, idx, src)
def _segment_sum(src, seg, n):
    out = torch.zeros((n,) + src.shape[1:], dtype=src.dtype)
    return out.index_add_(0, seg, src)
def _pad(x, pw):
    flat = tuple(v for pair in reversed(pw) for v in pair)
    return torch.nn.functional.pad(x, flat)

kernel_name = 'parallel_sum__ssm_conv_h3__geglu_ffn__prompt'

def setup_inputs():

    _w = (lambda a: (lambda t: t.to(torch.bfloat16) if t.is_floating_point() else t)(torch.as_tensor(a)))
    def _A_setup():
        B, S, D = 1, 2048, 512
        ks = 4
        return {
            "q": _w((lambda *s: torch.randn(*s, dtype=torch.bfloat16) * 0.05)(B, S, D)),
            "k": _w((lambda *s: torch.randn(*s, dtype=torch.bfloat16) * 0.8)(B, S, D)),
            "v": _w((lambda *s: torch.randn(*s, dtype=torch.bfloat16) * 0.8)(B, S, D)),
            "shift_k": _w((lambda *s: torch.randn(*s, dtype=torch.bfloat16) * 0.8)(D, ks) * 0.5),
            "ssm_k": _w((lambda *s: torch.randn(*s, dtype=torch.bfloat16) * 0.8)(D, S) * (1.0 / S ** 0.5)),
            "ssm_D": _w((lambda *s: torch.randn(*s, dtype=torch.bfloat16) * 0.8)(D)),
        }
    _A_in = _A_setup()

    def _B_setup():
        B, S, D, F = 1, 2048, 512, 1792
        return {
            "x": _w((lambda *s: torch.randn(*s, dtype=torch.bfloat16) * 0.05)(B, S, D)),
            "w_gate": _w((lambda *s: torch.randn(*s, dtype=torch.bfloat16) * 0.05)(D, F)),
            "w_up": _w((lambda *s: torch.randn(*s, dtype=torch.bfloat16) * 0.05)(D, F)),
            "w_down": _w((lambda *s: torch.randn(*s, dtype=torch.bfloat16) * 0.05)(F, D)),
        }
    _B_in = _B_setup()

    return {
        "A_q": _A_in["q"],
        "A_k": _A_in["k"],
        "A_v": _A_in["v"],
        "A_shift_k": _A_in["shift_k"],
        "A_ssm_k": _A_in["ssm_k"],
        "A_ssm_D": _A_in["ssm_D"],
        "B_x": _B_in["x"],
        "B_w_gate": _B_in["w_gate"],
        "B_w_up": _B_in["w_up"],
        "B_w_down": _B_in["w_down"],
    }

def reference(A_q, A_k, A_v, A_shift_k, A_ssm_k, A_ssm_D, B_x, B_w_gate, B_w_up, B_w_down):
    def _A_ref(q, k, v, shift_k, ssm_k, ssm_D):
        B, S, D = q.shape
        ks = shift_k.shape[-1]
        k_pad = _pad(k, ((0, 0), (ks - 1, 0), (0, 0)))
        k_shift = torch.zeros_like(k)
        for t in range(ks):
            k_shift = k_shift + k_pad[:, t:t + S, :] * shift_k[:, ks - 1 - t][None, None, :]
        kv = k_shift * v
        L = 2 * S
        kv_pad = _pad(kv, ((0, 0), (0, S), (0, 0)))
        kf_pad = _pad(ssm_k, ((0, 0), (0, S)))
        kv_f = (lambda x, axes=(-2,-1): torch.fft.rfft2(x.float(), dim=axes))(kv_pad[:, None, :, :], axes=(1, 2))
        kf_f = (lambda x, axes=(-2,-1): torch.fft.rfft2(x.float(), dim=axes))(kf_pad[:, None, :], axes=(1, 2))
        kf_f = (lambda x, *d: x.permute(*d))(kf_f, 1, 2, 0)
        y_f = kv_f * kf_f[None, :, :, :]
        y = (lambda x, s, axes=(-2,-1): torch.fft.irfft2(x, s=s, dim=axes).to(torch.bfloat16))(y_f, (1, L), axes=(1, 2))[:, 0, :S, :]
        y = y + kv * ssm_D[None, None, :]
        return q * y

    def _B_ref(x, w_gate, w_up, w_down):
        return (_gelu(x @ w_gate) * (x @ w_up)) @ w_down

    x = A_q
    xn = _layernorm(x, axis=-1)
    return x + _A_ref(xn, A_k, A_v, A_shift_k, A_ssm_k, A_ssm_D) + _B_ref(xn, B_w_gate, B_w_up, B_w_down)
```

```asm
; @launch kernel=fused_kernel grid=(256,1,1) block=(512,1,1) lds=160768
.amdgcn_target "amdgcn-amd-amdhsa--gfx950"
.text
.globl fused_kernel
.p2align 8
.type fused_kernel,@function
fused_kernel:
  s_cmp_ge_u32 s2, 256
  s_cbranch_scc1 K_end
  s_load_dwordx2 s[4:5], s[0:1], 0
  s_load_dwordx4 s[8:11], s[0:1], 56
  s_load_dwordx2 s[16:17], s[0:1], 96
  s_load_dwordx4 s[56:59], s[0:1], 32
  s_load_dwordx4 s[12:15], s[0:1], 80
  s_load_dwordx4 s[64:67], s[0:1], 8
  s_load_dwordx2 s[96:97], s[0:1], 24
  s_getpc_b64 s[24:25]
K_pc:
  v_lshlrev_b32 v1, 6, v0
  v_cmp_gt_u32 vcc, K_codeend-K_pc-64, v1
  s_mov_b64 exec, vcc
  s_cbranch_execz K_nopf
  global_load_dword v255, v1, s[24:25]
K_nopf:
  s_mov_b64 exec, -1
  v_lshrrev_b32 v1, 6, v0
  v_and_b32 v23, 63, v0
  s_and_b32 s26, s2, 7
  s_lshr_b32 s27, s2, 3
  v_readfirstlane_b32 s20, v1
  v_lshrrev_b32 v24, 4, v23
  v_and_b32 v25, 15, v23
  s_cmp_ge_u32 s27, 28
  s_cbranch_scc1 K_pre
  s_and_b32 s28, s26, 3
  s_lshl_b32 s28, s28, 2
  s_and_b32 s30, s27, 3
  s_add_u32 s28, s28, s30
  s_lshr_b32 s29, s26, 2
  s_mul_i32 s29, s29, 7
  s_lshr_b32 s30, s27, 2
  s_add_u32 s29, s29, s30
  s_lshr_b32 s31, s20, 2
  v_lshlrev_b32 v26, 2, v24
  s_lshl_b32 s30, s31, 1
  v_or_b32 v26, s30, v26
  v_xor_b32 v26, v26, v25
  v_lshlrev_b32 v26, 4, v26
  s_and_b32 s30, s20, 3
  s_lshl_b32 s30, s30, 4
  v_add_u32 v27, s30, v24
  v_mul_u32_u24 v27, 3584, v27
  v_add_u32 v10, v27, v26
  v_add_u32 v11, 13312, v10
  v_add_u32 v12, 26624, v10
  v_add_u32 v13, 39936, v10
  v_lshrrev_b32 v26, 3, v23
  v_and_b32 v27, 7, v23
  v_xor_b32 v27, v27, v24
  v_lshlrev_b32 v27, 4, v27
  v_lshl_add_u32 v14, v26, 10, v27
  v_xor_b32 v15, 64, v14
  v_add_u32 v15, 7168, v15
  s_lshl_b32 s21, s28, 17
  s_lshl_b32 s30, s20, 14
  s_add_u32 s21, s21, s30
  s_lshl_b32 s22, s29, 8
  s_lshl_b32 s32, s20, 11
  s_lshl_b32 s33, s20, 12
  s_add_u32 s33, s33, 49152
  s_waitcnt lgkmcnt(0)
  s_cmp_eq_u32 s31, 1
  s_cselect_b32 s8, s10, s8
  s_cselect_b32 s9, s11, s9
  s_mov_b32 s6, 2097152
  s_mov_b32 s7, 0x20000
  s_mov_b32 s10, 1835008
  s_mov_b32 s11, 0x20000
  s_mov_b32 s18, 16777216
  s_mov_b32 s19, 0x20000
  s_add_u32 m0, s33, 0
  s_nop 0
  buffer_load_dwordx4 v10, s[8:11], s22 offen offset:0 lds
  buffer_load_dwordx4 v11, s[8:11], s22 offen offset:1024 lds
  buffer_load_dwordx4 v12, s[8:11], s22 offen offset:2048 lds
  buffer_load_dwordx4 v13, s[8:11], s22 offen offset:3072 lds
  s_add_u32 m0, s32, 0
  s_add_u32 s22, s22, 229376
  buffer_load_dwordx4 v14, s[4:7], s21 offen offset:0 lds
  buffer_load_dwordx4 v15, s[4:7], s21 offen offset:1024 lds
  s_add_u32 s21, s21, 128
  s_and_b32 s34, s20, 1
  s_lshr_b32 s35, s20, 1
  v_and_b32 v26, 1, v24
  v_lshrrev_b32 v27, 5, v23
  v_bfe_u32 v28, v23, 2, 2
  v_lshl_add_u32 v29, v27, 3, v28
  v_lshlrev_b32 v29, 8, v29
  v_lshl_add_u32 v29, v26, 14, v29
  v_and_b32 v30, 3, v23
  v_lshl_add_u32 v29, v30, 3, v29
  v_add_u32 v29, 49152, v29
  v_lshl_add_u32 v30, v28, 1, v26
  s_lshl_b32 s30, s35, 1
  s_add_u32 s30, s30, 0
  v_xor_b32 v31, s30, v30
  v_lshl_add_u32 v31, v31, 5, v29
  s_xor_b32 s30, s34, 0
  s_lshl_b32 s30, s30, 12
  v_add_u32 v176, s30, v31
  v_add_u32 v180, 65536, v176
  s_xor_b32 s30, s34, 1
  s_lshl_b32 s30, s30, 12
  v_add_u32 v178, s30, v31
  v_add_u32 v182, 65536, v178
  s_lshl_b32 s30, s35, 1
  s_add_u32 s30, s30, 1
  v_xor_b32 v31, s30, v30
  v_lshl_add_u32 v31, v31, 5, v29
  s_xor_b32 s30, s34, 0
  s_lshl_b32 s30, s30, 12
  v_add_u32 v177, s30, v31
  v_add_u32 v181, 65536, v177
  s_xor_b32 s30, s34, 1
  s_lshl_b32 s30, s30, 12
  v_add_u32 v179, s30, v31
  v_add_u32 v183, 65536, v179
  v_and_b32 v26, 31, v23
  s_lshl_b32 s30, s34, 13
  v_lshlrev_b32 v28, 7, v26
  v_add_u32 v28, s30, v28
  v_bfe_u32 v29, v23, 1, 3
  v_xor_b32 v29, v29, v27
  s_xor_b32 s30, s34, 0
  s_lshl_b32 s30, s30, 1
  v_xor_b32 v30, s30, v29
  v_lshl_add_u32 v6, v30, 4, v28
  s_xor_b32 s30, s34, 1
  s_lshl_b32 s30, s30, 1
  v_xor_b32 v30, s30, v29
  v_lshl_add_u32 v7, v30, 4, v28
  s_xor_b32 s30, s34, 2
  s_lshl_b32 s30, s30, 1
  v_xor_b32 v30, s30, v29
  v_lshl_add_u32 v8, v30, 4, v28
  s_xor_b32 s30, s34, 3
  s_lshl_b32 s30, s30, 1
  v_xor_b32 v30, s30, v29
  v_lshl_add_u32 v9, v30, 4, v28
  s_add_u32 m0, s33, 32768
  s_nop 0
  buffer_load_dwordx4 v10, s[8:11], s22 offen offset:0 lds
  buffer_load_dwordx4 v11, s[8:11], s22 offen offset:1024 lds
  buffer_load_dwordx4 v12, s[8:11], s22 offen offset:2048 lds
  buffer_load_dwordx4 v13, s[8:11], s22 offen offset:3072 lds
  s_add_u32 m0, s32, 16384
  s_add_u32 s22, s22, 229376
  buffer_load_dwordx4 v14, s[4:7], s21 offen offset:0 lds
  buffer_load_dwordx4 v15, s[4:7], s21 offen offset:1024 lds
  s_add_u32 s21, s21, 128
  v_lshrrev_b32 v28, 2, v23
  v_bfe_u32 v29, v23, 4, 1
  v_xor_b32 v28, v28, v29
  v_and_b32 v28, 3, v28
  v_mov_b32 v29, 0x3f803f80
  v_cmp_eq_u32 vcc, 0, v28
  v_cndmask_b32 v192, 0, v29, vcc
  v_mov_b32 v193, v192
  v_mov_b32 v194, v192
  v_mov_b32 v195, v192
  v_cmp_eq_u32 vcc, 2, v28
  v_cndmask_b32 v196, 0, v29, vcc
  v_mov_b32 v197, v196
  v_mov_b32 v198, v196
  v_mov_b32 v199, v196
  s_lshl_b32 s30, s35, 9
  s_add_u32 s30, s30, 148480
  v_lshl_add_u32 v2, v23, 3, s30
  v_lshl_add_u32 v5, s34, 2, v2
  v_lshlrev_b32 v4, 3, v23
  s_and_b32 s50, s26, 3
  s_lshl_b32 s50, s50, 3
  s_and_b32 s30, s27, 7
  s_add_u32 s50, s50, s30
  s_lshr_b32 s51, s26, 2
  s_lshl_b32 s51, s51, 2
  s_lshr_b32 s30, s27, 3
  s_add_u32 s51, s51, s30
  s_mov_b64 s[44:45], s[14:15]
  s_mov_b32 s46, 256
  s_mov_b32 s47, 0x20000
  s_mov_b32 s14, 2097152
  s_mov_b32 s15, 0x20000
  s_lshr_b32 s48, s20, 2
  s_lshl_b32 s36, s2, 1
  s_add_u32 s36, s36, s48
  s_lshl_b32 s30, s36, 12
  s_add_u32 s40, s56, s30
  s_addc_u32 s41, s57, 0
  s_mov_b32 s42, 4096
  s_mov_b32 s43, 0x20000
  s_lshl_b32 s30, s2, 2
  s_load_dword s37, s[58:59], s30
  v_and_b32 v28, 255, v0
  v_lshlrev_b32 v28, 4, v28
  v_subrev_u32 v26, 16, v28
  v_max_i32 v27, 0, v26
  s_lshl_b32 s39, s20, 24
  s_add_u32 s39, s39, 14745600
  s_lshl_b32 s23, s2, 7
  s_add_u32 s23, s23, s39
  s_lshr_b32 s30, s2, 5
  v_lshl_add_u32 v242, v23, 3, s30
  s_lshl_b32 s30, s51, 2
  s_add_u32 s30, s30, 192
  v_add_u32 v243, s30, v23
  v_cmp_gt_u32 vcc, 32, v23
  v_cndmask_b32 v242, v243, v242, vcc
  s_add_u32 s30, s50, 256
  v_mov_b32 v243, s30
  v_cmp_gt_u32 vcc, 36, v23
  v_cndmask_b32 v242, v243, v242, vcc
  v_lshl_add_u32 v242, v242, 7, s39
  s_lshl_b32 s30, s28, 1
  s_add_u32 s30, s30, s34
  s_lshl_b32 s53, s30, 9
  s_add_u32 s53, s53, 14680064
  s_mul_i32 s30, s30, 56
  s_lshl_b32 s38, s29, 2
  s_add_u32 s38, s38, s35
  s_add_u32 s38, s38, s30
  s_lshl_b32 s52, s38, 7
  s_add_u32 s52, s52, 14811136
  s_lshl_b32 s38, s38, 12
  s_lshl_b32 s30, s28, 1
  s_add_u32 s30, s30, s34
  s_lshl_b32 s30, s30, 7
  s_add_u32 s61, s30, 14778368
  v_mov_b32 v243, s61
  s_mov_b64 s[92:93], s[66:67]
  s_mov_b32 s66, 2097152
  s_mov_b32 s67, 0x20000
  s_mov_b32 s94, 2097152
  s_mov_b32 s95, 0x20000
  s_mov_b32 s98, 4096
  s_mov_b32 s99, 0x20000
  v_lshrrev_b32 v236, 3, v23
  v_and_b32 v237, 7, v23
  v_mul_u32_u24 v236, 3584, v236
  v_lshl_add_u32 v236, v237, 5, v236
  s_lshl_b32 s30, s28, 2
  s_and_b32 s31, s20, 3
  s_add_u32 s30, s30, s31
  s_mul_i32 s30, s30, 28672
  s_lshl_b32 s60, s29, 8
  s_add_u32 s30, s30, s60
  buffer_load_dword v254, v236, s[8:11], s30 offen
  v_mov_b32 v238, 0
  s_waitcnt vmcnt(7) lgkmcnt(0)
  s_barrier
  s_load_dwordx2 s[68:69], s[44:45], 0
  ds_read_b128 v[160:163], v6 offset:0
  ds_read_b64_tr_b16 v[144:145], v176 offset:0
  ds_read_b64_tr_b16 v[146:147], v176 offset:1024
  ds_read_b128 v[164:167], v6 offset:4096
  ds_read_b64_tr_b16 v[148:149], v177 offset:0
  ds_read_b64_tr_b16 v[150:151], v177 offset:1024
  ds_read_b128 v[168:171], v7 offset:0
  ds_read_b64_tr_b16 v[152:153], v178 offset:0
  ds_read_b64_tr_b16 v[154:155], v178 offset:1024
  ds_read_b128 v[172:175], v7 offset:4096
  ds_read_b64_tr_b16 v[156:157], v179 offset:0
  ds_read_b64_tr_b16 v[158:159], v179 offset:1024
  s_waitcnt lgkmcnt(6)
  v_mfma_f32_32x32x16_bf16 v[32:47], v[144:147], v[160:163], 0
  s_add_u32 m0, s33, 65536
  s_nop 0
  buffer_load_dwordx4 v10, s[8:11], s22 offen offset:0 lds
  buffer_load_dwordx4 v11, s[8:11], s22 offen offset:1024 lds
  v_mfma_f32_32x32x16_bf16 v[48:63], v[144:147], v[164:167], 0
  v_mfma_f32_16x16x32_bf16 v[200:203], v[192:195], v[144:147], 0
  buffer_load_dwordx4 v12, s[8:11], s22 offen offset:2048 lds
  buffer_load_dwordx4 v13, s[8:11], s22 offen offset:3072 lds
  v_mfma_f32_32x32x16_bf16 v[64:79], v[148:151], v[160:163], 0
  s_add_u32 m0, s32, 32768
  s_add_u32 s22, s22, 229376
  buffer_load_dwordx4 v14, s[4:7], s21 offen offset:0 lds
  buffer_load_dwordx4 v15, s[4:7], s21 offen offset:1024 lds
  s_add_u32 s21, s21, 128
  v_mfma_f32_32x32x16_bf16 v[80:95], v[148:151], v[164:167], 0
  ds_read_b128 v[160:163], v8 offset:0
  ds_read_b64_tr_b16 v[144:145], v176 offset:8192
  ds_read_b64_tr_b16 v[146:147], v176 offset:9216
  ds_read_b128 v[164:167], v8 offset:4096
  ds_read_b64_tr_b16 v[148:149], v177 offset:8192
  ds_read_b64_tr_b16 v[150:151], v177 offset:9216
  s_waitcnt lgkmcnt(6)
  v_mfma_f32_32x32x16_bf16 v[32:47], v[152:155], v[168:171], v[32:47]
  v_mfma_f32_32x32x16_bf16 v[48:63], v[152:155], v[172:175], v[48:63]
  v_mfma_f32_16x16x32_bf16 v[200:203], v[196:199], v[156:159], v[200:203]
  v_mfma_f32_32x32x16_bf16 v[64:79], v[156:159], v[168:171], v[64:79]
  v_mfma_f32_32x32x16_bf16 v[80:95], v[156:159], v[172:175], v[80:95]
  ds_read_b128 v[168:171], v9 offset:0
  ds_read_b64_tr_b16 v[152:153], v178 offset:8192
  ds_read_b64_tr_b16 v[154:155], v178 offset:9216
  ds_read_b128 v[172:175], v9 offset:4096
  ds_read_b64_tr_b16 v[156:157], v179 offset:8192
  ds_read_b64_tr_b16 v[158:159], v179 offset:9216
  s_waitcnt lgkmcnt(6)
  v_mfma_f32_32x32x16_bf16 v[32:47], v[144:147], v[160:163], v[32:47]
  v_mfma_f32_32x32x16_bf16 v[48:63], v[144:147], v[164:167], v[48:63]
  v_mfma_f32_16x16x32_bf16 v[200:203], v[192:195], v[144:147], v[200:203]
  v_mfma_f32_32x32x16_bf16 v[64:79], v[148:151], v[160:163], v[64:79]
  v_mfma_f32_32x32x16_bf16 v[80:95], v[148:151], v[164:167], v[80:95]
  s_cmp_ge_u32 s20, 4
  s_cbranch_scc1 K_kl
  v_and_b32 v236, 7, v23
  v_lshrrev_b32 v237, 3, v23
  s_lshl_b32 s30, s27, 16
  s_lshl_b32 s31, s26, 7
  s_add_u32 s30, s30, s31
  s_lshl_b32 s31, s20, 5
  s_add_u32 s30, s30, s31
  v_lshlrev_b32 v238, 13, v236
  v_lshl_add_u32 v238, v237, 2, v238
  v_add_u32 v238, s30, v238
  v_subrev_u32 v239, 3072, v238
  s_lshl_b32 s30, s26, 9
  s_lshl_b32 s31, s20, 7
  s_add_u32 s30, s30, s31
  v_lshrrev_b32 v240, 3, v23
  v_lshlrev_b32 v240, 4, v240
  s_movk_i32 s31, 4096
  buffer_load_dword v204, v239, s[64:67], 0 offen offset:0
  buffer_load_dword v205, v239, s[64:67], 0 offen offset:1024
  buffer_load_dword v206, v239, s[64:67], 0 offen offset:2048
  buffer_load_dword v207, v238, s[64:67], 0 offen offset:0
  buffer_load_dword v208, v238, s[64:67], 0 offen offset:1024
  buffer_load_dword v209, v238, s[64:67], 0 offen offset:2048
  buffer_load_dword v210, v238, s[64:67], 0 offen offset:3072
  buffer_load_dword v211, v238, s[64:67], s31 offen offset:0
  buffer_load_dword v212, v238, s[64:67], s31 offen offset:1024
  buffer_load_dword v213, v238, s[64:67], s31 offen offset:2048
  buffer_load_dword v214, v238, s[64:67], s31 offen offset:3072
K_kl:
  s_cmp_lt_u32 s20, 4
  s_cbranch_scc1 K_w0_a
  s_waitcnt vmcnt(7)
K_w0_a:
  s_waitcnt vmcnt(18) lgkmcnt(0)
  s_barrier
  ds_read_b128 v[160:163], v6 offset:16384
  ds_read_b64_tr_b16 v[144:145], v176 offset:32768
  ds_read_b64_tr_b16 v[146:147], v176 offset:33792
  ds_read_b128 v[164:167], v6 offset:20480
  ds_read_b64_tr_b16 v[148:149], v177 offset:32768
  ds_read_b64_tr_b16 v[150:151], v177 offset:33792
  v_mfma_f32_32x32x16_bf16 v[32:47], v[152:155], v[168:171], v[32:47]
  s_add_u32 m0, s33, 0
  s_nop 0
  buffer_load_dwordx4 v10, s[8:11], s22 offen offset:0 lds
  v_mfma_f32_32x32x16_bf16 v[48:63], v[152:155], v[172:175], v[48:63]
  v_mfma_f32_16x16x32_bf16 v[200:203], v[196:199], v[156:159], v[200:203]
  v_mfma_f32_32x32x16_bf16 v[64:79], v[156:159], v[168:171], v[64:79]
  buffer_load_dwordx4 v11, s[8:11], s22 offen offset:1024 lds
  v_mfma_f32_32x32x16_bf16 v[80:95], v[156:159], v[172:175], v[80:95]
  ds_read_b128 v[168:171], v7 offset:16384
  ds_read_b64_tr_b16 v[152:153], v178 offset:32768
  ds_read_b64_tr_b16 v[154:155], v178 offset:33792
  ds_read_b128 v[172:175], v7 offset:20480
  ds_read_b64_tr_b16 v[156:157], v179 offset:32768
  ds_read_b64_tr_b16 v[158:159], v179 offset:33792
  s_waitcnt lgkmcnt(6)
  v_mfma_f32_32x32x16_bf16 v[32:47], v[144:147], v[160:163], v[32:47]
  buffer_load_dwordx4 v12, s[8:11], s22 offen offset:2048 lds
  v_mfma_f32_32x32x16_bf16 v[48:63], v[144:147], v[164:167], v[48:63]
  v_mfma_f32_16x16x32_bf16 v[200:203], v[192:195], v[144:147], v[200:203]
  v_mfma_f32_32x32x16_bf16 v[64:79], v[148:151], v[160:163], v[64:79]
  buffer_load_dwordx4 v13, s[8:11], s22 offen offset:3072 lds
  v_mfma_f32_32x32x16_bf16 v[80:95], v[148:151], v[164:167], v[80:95]
  ds_read_b128 v[160:163], v8 offset:16384
  ds_read_b64_tr_b16 v[144:145], v176 offset:40960
  ds_read_b64_tr_b16 v[146:147], v176 offset:41984
  ds_read_b128 v[164:167], v8 offset:20480
  ds_read_b64_tr_b16 v[148:149], v177 offset:40960
  ds_read_b64_tr_b16 v[150:151], v177 offset:41984
  s_waitcnt lgkmcnt(6)
  v_mfma_f32_32x32x16_bf16 v[32:47], v[152:155], v[168:171], v[32:47]
  s_add_u32 m0, s32, 0
  s_add_u32 s22, s22, 229376
  buffer_load_dwordx4 v14, s[4:7], s21 offen offset:0 lds
  v_mfma_f32_32x32x16_bf16 v[48:63], v[152:155], v[172:175], v[48:63]
  v_mfma_f32_16x16x32_bf16 v[200:203], v[196:199], v[156:159], v[200:203]
  v_mfma_f32_32x32x16_bf16 v[64:79], v[156:159], v[168:171], v[64:79]
  buffer_load_dwordx4 v15, s[4:7], s21 offen offset:1024 lds
  s_add_u32 s21, s21, 128
  v_mfma_f32_32x32x16_bf16 v[80:95], v[156:159], v[172:175], v[80:95]
  ds_read_b128 v[168:171], v9 offset:16384
  ds_read_b64_tr_b16 v[152:153], v178 offset:40960
  ds_read_b64_tr_b16 v[154:155], v178 offset:41984
  ds_read_b128 v[172:175], v9 offset:20480
  ds_read_b64_tr_b16 v[156:157], v179 offset:40960
  ds_read_b64_tr_b16 v[158:159], v179 offset:41984
  s_waitcnt lgkmcnt(6)
  v_mfma_f32_32x32x16_bf16 v[32:47], v[144:147], v[160:163], v[32:47]
  v_mfma_f32_32x32x16_bf16 v[48:63], v[144:147], v[164:167], v[48:63]
  v_mfma_f32_16x16x32_bf16 v[200:203], v[192:195], v[144:147], v[200:203]
  v_mfma_f32_32x32x16_bf16 v[64:79], v[148:151], v[160:163], v[64:79]
  v_mfma_f32_32x32x16_bf16 v[80:95], v[148:151], v[164:167], v[80:95]
  s_cmp_ge_u32 s20, 4
  s_cbranch_scc1 K_km
  s_lshl_b32 s30, s26, 9
  s_lshl_b32 s31, s20, 7
  s_add_u32 s30, s30, s31
  v_lshrrev_b32 v240, 3, v23
  v_lshlrev_b32 v240, 4, v240
  s_movk_i32 s31, 4096
  buffer_load_dwordx4 v[224:227], v240, s[96:99], s30 offen
  buffer_load_dword v215, v238, s[92:95], 0 offen offset:0
  buffer_load_dword v216, v238, s[92:95], 0 offen offset:1024
  buffer_load_dword v217, v238, s[92:95], 0 offen offset:2048
  buffer_load_dword v218, v238, s[92:95], 0 offen offset:3072
  buffer_load_dword v219, v238, s[92:95], s31 offen offset:0
  buffer_load_dword v220, v238, s[92:95], s31 offen offset:1024
  buffer_load_dword v221, v238, s[92:95], s31 offen offset:2048
  buffer_load_dword v222, v238, s[92:95], s31 offen offset:3072
K_km:
  s_cmp_lt_u32 s20, 4
  s_cbranch_scc1 K_w1_a
  s_waitcnt vmcnt(6)
K_w1_a:
  s_waitcnt vmcnt(26) lgkmcnt(0)
  s_barrier
  ds_read_b128 v[160:163], v6 offset:32768
  ds_read_b64_tr_b16 v[144:145], v180 offset:0
  ds_read_b64_tr_b16 v[146:147], v180 offset:1024
  ds_read_b128 v[164:167], v6 offset:36864
  ds_read_b64_tr_b16 v[148:149], v181 offset:0
  ds_read_b64_tr_b16 v[150:151], v181 offset:1024
  v_mfma_f32_32x32x16_bf16 v[32:47], v[152:155], v[168:171], v[32:47]
  s_add_u32 m0, s33, 32768
  s_nop 0
  buffer_load_dwordx4 v10, s[8:11], s22 offen offset:0 lds
  v_mfma_f32_32x32x16_bf16 v[48:63], v[152:155], v[172:175], v[48:63]
  v_mfma_f32_16x16x32_bf16 v[200:203], v[196:199], v[156:159], v[200:203]
  v_mfma_f32_32x32x16_bf16 v[64:79], v[156:159], v[168:171], v[64:79]
  buffer_load_dwordx4 v11, s[8:11], s22 offen offset:1024 lds
  v_mfma_f32_32x32x16_bf16 v[80:95], v[156:159], v[172:175], v[80:95]
  ds_read_b128 v[168:171], v7 offset:32768
  ds_read_b64_tr_b16 v[152:153], v182 offset:0
  ds_read_b64_tr_b16 v[154:155], v182 offset:1024
  ds_read_b128 v[172:175], v7 offset:36864
  ds_read_b64_tr_b16 v[156:157], v183 offset:0
  ds_read_b64_tr_b16 v[158:159], v183 offset:1024
  s_waitcnt lgkmcnt(6)
  v_mfma_f32_32x32x16_bf16 v[32:47], v[144:147], v[160:163], v[32:47]
  buffer_load_dwordx4 v12, s[8:11], s22 offen offset:2048 lds
  v_mfma_f32_32x32x16_bf16 v[48:63], v[144:147], v[164:167], v[48:63]
  v_mfma_f32_16x16x32_bf16 v[200:203], v[192:195], v[144:147], v[200:203]
  v_mfma_f32_32x32x16_bf16 v[64:79], v[148:151], v[160:163], v[64:79]
  buffer_load_dwordx4 v13, s[8:11], s22 offen offset:3072 lds
  v_mfma_f32_32x32x16_bf16 v[80:95], v[148:151], v[164:167], v[80:95]
  ds_read_b128 v[160:163], v8 offset:32768
  ds_read_b64_tr_b16 v[144:145], v180 offset:8192
  ds_read_b64_tr_b16 v[146:147], v180 offset:9216
  ds_read_b128 v[164:167], v8 offset:36864
  ds_read_b64_tr_b16 v[148:149], v181 offset:8192
  ds_read_b64_tr_b16 v[150:151], v181 offset:9216
  s_waitcnt lgkmcnt(6)
  v_mfma_f32_32x32x16_bf16 v[32:47], v[152:155], v[168:171], v[32:47]
  s_add_u32 m0, s32, 16384
  s_add_u32 s22, s22, 229376
  buffer_load_dwordx4 v14, s[4:7], s21 offen offset:0 lds
  v_mfma_f32_32x32x16_bf16 v[48:63], v[152:155], v[172:175], v[48:63]
  v_mfma_f32_16x16x32_bf16 v[200:203], v[196:199], v[156:159], v[200:203]
  v_mfma_f32_32x32x16_bf16 v[64:79], v[156:159], v[168:171], v[64:79]
  buffer_load_dwordx4 v15, s[4:7], s21 offen offset:1024 lds
  s_add_u32 s21, s21, 128
  v_mfma_f32_32x32x16_bf16 v[80:95], v[156:159], v[172:175], v[80:95]
  ds_read_b128 v[168:171], v9 offset:32768
  ds_read_b64_tr_b16 v[152:153], v182 offset:8192
  ds_read_b64_tr_b16 v[154:155], v182 offset:9216
  ds_read_b128 v[172:175], v9 offset:36864
  ds_read_b64_tr_b16 v[156:157], v183 offset:8192
  ds_read_b64_tr_b16 v[158:159], v183 offset:9216
  s_waitcnt lgkmcnt(6)
  v_mfma_f32_32x32x16_bf16 v[32:47], v[144:147], v[160:163], v[32:47]
  v_mfma_f32_32x32x16_bf16 v[48:63], v[144:147], v[164:167], v[48:63]
  v_mfma_f32_16x16x32_bf16 v[200:203], v[192:195], v[144:147], v[200:203]
  v_mfma_f32_32x32x16_bf16 v[64:79], v[148:151], v[160:163], v[64:79]
  v_mfma_f32_32x32x16_bf16 v[80:95], v[148:151], v[164:167], v[80:95]
  s_waitcnt vmcnt(6) lgkmcnt(0)
  s_cmp_lg_u64 s[68:69], 0
  s_cbranch_scc1 K_pn_x
  s_mov_b32 s62, 0x4000
K_pn:
  s_sleep 3
  buffer_load_dwordx2 v[30:31], off, s[44:47], 0 sc1
  s_sub_u32 s62, s62, 1
  s_waitcnt vmcnt(0)
K_pn_c:
  v_cmp_eq_u64 vcc, 0, v[30:31]
  s_cmp_eq_u32 s62, 0
  s_cbranch_scc1 K_pn_y
  s_cmp_lg_u64 vcc, 0
  s_cbranch_scc1 K_pn
K_pn_y:
  v_readfirstlane_b32 s68, v30
  v_readfirstlane_b32 s69, v31
  s_nop 1
K_pn_x:
  s_barrier
  ds_read_b128 v[160:163], v6 offset:0
  ds_read_b64_tr_b16 v[144:145], v176 offset:0
  ds_read_b64_tr_b16 v[146:147], v176 offset:1024
  ds_read_b128 v[164:167], v6 offset:4096
  ds_read_b64_tr_b16 v[148:149], v177 offset:0
  ds_read_b64_tr_b16 v[150:151], v177 offset:1024
  v_mfma_f32_32x32x16_bf16 v[32:47], v[152:155], v[168:171], v[32:47]
  s_add_u32 m0, s33, 65536
  s_nop 0
  buffer_load_dwordx4 v10, s[8:11], s22 offen offset:0 lds
  v_mfma_f32_32x32x16_bf16 v[48:63], v[152:155], v[172:175], v[48:63]
  v_mfma_f32_16x16x32_bf16 v[200:203], v[196:199], v[156:159], v[200:203]
  v_mfma_f32_32x32x16_bf16 v[64:79], v[156:159], v[168:171], v[64:79]
  buffer_load_dwordx4 v11, s[8:11], s22 offen offset:1024 lds
  v_mfma_f32_32x32x16_bf16 v[80:95], v[156:159], v[172:175], v[80:95]
  s_cmp_lt_u32 s20, 4
  s_cbranch_scc1 K_kc_k
  v_lshlrev_b32 v240, 4, v23
  s_lshl_b32 s30, s2, 13
  s_lshl_b32 s31, s20, 11
  s_add_u32 s30, s30, s31
  s_add_u32 s30, s30, 12574720
  v_mov_b32 v228, -1
  v_mov_b32 v229, -1
  v_mov_b32 v230, -1
  v_mov_b32 v231, -1
  buffer_store_dwordx4 v[228:231], v240, s[16:19], s30 offen sc1
  buffer_store_dwordx4 v[228:231], v240, s[16:19], s30 offen offset:1024 sc1
  s_branch K_kc_e
K_kc_k:
  v_lshlrev_b32 v134, 16, v224
  v_lshlrev_b32 v135, 16, v226
  v_and_b32 v136, 0xffff0000, v224
  v_and_b32 v137, 0xffff0000, v226
  v_lshlrev_b32 v138, 16, v225
  v_lshlrev_b32 v139, 16, v227
  v_and_b32 v140, 0xffff0000, v225
  v_and_b32 v141, 0xffff0000, v227
  v_lshlrev_b32 v96, 16, v204
  v_and_b32 v97, 0xffff0000, v204
  v_lshlrev_b32 v98, 16, v205
  v_and_b32 v99, 0xffff0000, v205
  v_lshlrev_b32 v100, 16, v206
  v_and_b32 v101, 0xffff0000, v206
  v_lshlrev_b32 v102, 16, v207
  v_and_b32 v103, 0xffff0000, v207
  v_lshlrev_b32 v104, 16, v208
  v_and_b32 v105, 0xffff0000, v208
  v_lshlrev_b32 v106, 16, v209
  v_and_b32 v107, 0xffff0000, v209
  v_lshlrev_b32 v108, 16, v210
  v_and_b32 v109, 0xffff0000, v210
  v_lshlrev_b32 v110, 16, v211
  v_and_b32 v111, 0xffff0000, v211
  v_lshlrev_b32 v112, 16, v212
  v_and_b32 v113, 0xffff0000, v212
  v_lshlrev_b32 v114, 16, v213
  v_and_b32 v115, 0xffff0000, v213
  v_lshlrev_b32 v116, 16, v214
  v_and_b32 v117, 0xffff0000, v214
  v_pk_mul_f32 v[118:119], v[96:97], v[140:141]
  v_pk_mul_f32 v[120:121], v[98:99], v[140:141]
  v_pk_mul_f32 v[122:123], v[100:101], v[140:141]
  v_pk_mul_f32 v[124:125], v[102:103], v[140:141]
  v_pk_mul_f32 v[126:127], v[104:105], v[140:141]
  v_pk_mul_f32 v[128:129], v[106:107], v[140:141]
  v_pk_mul_f32 v[130:131], v[108:109], v[140:141]
  v_pk_mul_f32 v[132:133], v[110:111], v[140:141]
  v_pk_fma_f32 v[118:119], v[98:99], v[138:139], v[118:119]
  v_pk_fma_f32 v[120:121], v[100:101], v[138:139], v[120:121]
  v_pk_fma_f32 v[122:123], v[102:103], v[138:139], v[122:123]
  v_pk_fma_f32 v[124:125], v[104:105], v[138:139], v[124:125]
  v_pk_fma_f32 v[126:127], v[106:107], v[138:139], v[126:127]
  v_pk_fma_f32 v[128:129], v[108:109], v[138:139], v[128:129]
  v_pk_fma_f32 v[130:131], v[110:111], v[138:139], v[130:131]
  v_pk_fma_f32 v[132:133], v[112:113], v[138:139], v[132:133]
  v_pk_fma_f32 v[118:119], v[100:101], v[136:137], v[118:119]
  v_pk_fma_f32 v[120:121], v[102:103], v[136:137], v[120:121]
  v_pk_fma_f32 v[122:123], v[104:105], v[136:137], v[122:123]
  v_pk_fma_f32 v[124:125], v[106:107], v[136:137], v[124:125]
  v_pk_fma_f32 v[126:127], v[108:109], v[136:137], v[126:127]
  v_pk_fma_f32 v[128:129], v[110:111], v[136:137], v[128:129]
  v_pk_fma_f32 v[130:131], v[112:113], v[136:137], v[130:131]
  v_pk_fma_f32 v[132:133], v[114:115], v[136:137], v[132:133]
  v_pk_fma_f32 v[118:119], v[102:103], v[134:135], v[118:119]
  v_pk_fma_f32 v[120:121], v[104:105], v[134:135], v[120:121]
  v_pk_fma_f32 v[122:123], v[106:107], v[134:135], v[122:123]
  v_pk_fma_f32 v[124:125], v[108:109], v[134:135], v[124:125]
  v_pk_fma_f32 v[126:127], v[110:111], v[134:135], v[126:127]
  v_pk_fma_f32 v[128:129], v[112:113], v[134:135], v[128:129]
  v_pk_fma_f32 v[130:131], v[114:115], v[134:135], v[130:131]
  v_pk_fma_f32 v[132:133], v[116:117], v[134:135], v[132:133]
  v_lshlrev_b32 v96, 16, v215
  v_and_b32 v97, 0xffff0000, v215
  v_lshlrev_b32 v98, 16, v216
  v_and_b32 v99, 0xffff0000, v216
  v_lshlrev_b32 v100, 16, v217
  v_and_b32 v101, 0xffff0000, v217
  v_lshlrev_b32 v102, 16, v218
  v_and_b32 v103, 0xffff0000, v218
  v_lshlrev_b32 v104, 16, v219
  v_and_b32 v105, 0xffff0000, v219
  v_lshlrev_b32 v106, 16, v220
  v_and_b32 v107, 0xffff0000, v220
  v_lshlrev_b32 v108, 16, v221
  v_and_b32 v109, 0xffff0000, v221
  v_lshlrev_b32 v110, 16, v222
  v_and_b32 v111, 0xffff0000, v222
  v_pk_mul_f32 v[118:119], v[118:119], v[96:97]
  v_pk_mul_f32 v[120:121], v[120:121], v[98:99]
  v_pk_mul_f32 v[122:123], v[122:123], v[100:101]
  v_pk_mul_f32 v[124:125], v[124:125], v[102:103]
  v_pk_mul_f32 v[126:127], v[126:127], v[104:105]
  v_pk_mul_f32 v[128:129], v[128:129], v[106:107]
  v_pk_mul_f32 v[130:131], v[130:131], v[108:109]
  v_pk_mul_f32 v[132:133], v[132:133], v[110:111]
  s_lshl_b32 s30, s2, 13
  s_lshl_b32 s31, s20, 11
  s_add_u32 s30, s30, s31
  s_add_u32 s30, s30, 10485760
  v_lshrrev_b32 v240, 3, v23
  v_and_b32 v241, 7, v23
  v_lshlrev_b32 v240, 8, v240
  v_lshl_add_u32 v240, v241, 4, v240
  v_cvt_pk_bf16_f32 v228, v132, v130
  v_cvt_pk_bf16_f32 v229, v128, v126
  v_cvt_pk_bf16_f32 v230, v124, v122
  v_cvt_pk_bf16_f32 v231, v120, v118
  buffer_store_dwordx4 v[228:231], v240, s[16:19], s30 offen offset:0 sc1
  v_cvt_pk_bf16_f32 v232, v133, v131
  v_cvt_pk_bf16_f32 v233, v129, v127
  v_cvt_pk_bf16_f32 v234, v125, v123
  v_cvt_pk_bf16_f32 v235, v121, v119
  buffer_store_dwordx4 v[232:235], v240, s[16:19], s30 offen offset:128 sc1
K_kc_e:
  ds_read_b128 v[168:171], v7 offset:0
  ds_read_b64_tr_b16 v[152:153], v178 offset:0
  ds_read_b64_tr_b16 v[154:155], v178 offset:1024
  ds_read_b128 v[172:175], v7 offset:4096
  ds_read_b64_tr_b16 v[156:157], v179 offset:0
  ds_read_b64_tr_b16 v[158:159], v179 offset:1024
  s_waitcnt lgkmcnt(6)
  v_mfma_f32_32x32x16_bf16 v[32:47], v[144:147], v[160:163], v[32:47]
  buffer_load_dwordx4 v12, s[8:11], s22 offen offset:2048 lds
  v_mfma_f32_32x32x16_bf16 v[48:63], v[144:147], v[164:167], v[48:63]
  v_mfma_f32_16x16x32_bf16 v[200:203], v[192:195], v[144:147], v[200:203]
  v_mfma_f32_32x32x16_bf16 v[64:79], v[148:151], v[160:163], v[64:79]
  buffer_load_dwordx4 v13, s[8:11], s22 offen offset:3072 lds
  v_mfma_f32_32x32x16_bf16 v[80:95], v[148:151], v[164:167], v[80:95]
  ds_read_b128 v[160:163], v8 offset:0
  ds_read_b64_tr_b16 v[144:145], v176 offset:8192
  ds_read_b64_tr_b16 v[146:147], v176 offset:9216
  ds_read_b128 v[164:167], v8 offset:4096
  ds_read_b64_tr_b16 v[148:149], v177 offset:8192
  ds_read_b64_tr_b16 v[150:151], v177 offset:9216
  s_waitcnt lgkmcnt(6)
  v_mfma_f32_32x32x16_bf16 v[32:47], v[152:155], v[168:171], v[32:47]
  s_add_u32 m0, s32, 32768
  s_add_u32 s22, s22, 229376
  buffer_load_dwordx4 v14, s[4:7], s21 offen offset:0 lds
  v_mfma_f32_32x32x16_bf16 v[48:63], v[152:155], v[172:175], v[48:63]
  v_mfma_f32_16x16x32_bf16 v[200:203], v[196:199], v[156:159], v[200:203]
  v_mfma_f32_32x32x16_bf16 v[64:79], v[156:159], v[168:171], v[64:79]
  buffer_load_dwordx4 v15, s[4:7], s21 offen offset:1024 lds
  s_add_u32 s21, s21, 128
  v_mfma_f32_32x32x16_bf16 v[80:95], v[156:159], v[172:175], v[80:95]
  ds_read_b128 v[168:171], v9 offset:0
  ds_read_b64_tr_b16 v[152:153], v178 offset:8192
  ds_read_b64_tr_b16 v[154:155], v178 offset:9216
  ds_read_b128 v[172:175], v9 offset:4096
  ds_read_b64_tr_b16 v[156:157], v179 offset:8192
  ds_read_b64_tr_b16 v[158:159], v179 offset:9216
  s_waitcnt lgkmcnt(6)
  v_mfma_f32_32x32x16_bf16 v[32:47], v[144:147], v[160:163], v[32:47]
  v_mfma_f32_32x32x16_bf16 v[48:63], v[144:147], v[164:167], v[48:63]
  v_mfma_f32_16x16x32_bf16 v[200:203], v[192:195], v[144:147], v[200:203]
  v_mfma_f32_32x32x16_bf16 v[64:79], v[148:151], v[160:163], v[64:79]
  v_mfma_f32_32x32x16_bf16 v[80:95], v[148:151], v[164:167], v[80:95]
  s_waitcnt vmcnt(8) lgkmcnt(0)
  s_barrier
  ds_read_b128 v[160:163], v6 offset:16384
  ds_read_b64_tr_b16 v[144:145], v176 offset:32768
  ds_read_b64_tr_b16 v[146:147], v176 offset:33792
  ds_read_b128 v[164:167], v6 offset:20480
  ds_read_b64_tr_b16 v[148:149], v177 offset:32768
  ds_read_b64_tr_b16 v[150:151], v177 offset:33792
  v_mfma_f32_32x32x16_bf16 v[32:47], v[152:155], v[168:171], v[32:47]
  s_add_u32 m0, s33, 0
  s_nop 0
  buffer_load_dwordx4 v10, s[8:11], s22 offen offset:0 lds
  v_mfma_f32_32x32x16_bf16 v[48:63], v[152:155], v[172:175], v[48:63]
  v_mfma_f32_16x16x32_bf16 v[200:203], v[196:199], v[156:159], v[200:203]
  v_mfma_f32_32x32x16_bf16 v[64:79], v[156:159], v[168:171], v[64:79]
  buffer_load_dwordx4 v11, s[8:11], s22 offen offset:1024 lds
  v_mfma_f32_32x32x16_bf16 v[80:95], v[156:159], v[172:175], v[80:95]
  ds_read_b128 v[168:171], v7 offset:16384
  ds_read_b64_tr_b16 v[152:153], v178 offset:32768
  ds_read_b64_tr_b16 v[154:155], v178 offset:33792
  ds_read_b128 v[172:175], v7 offset:20480
  ds_read_b64_tr_b16 v[156:157], v179 offset:32768
  ds_read_b64_tr_b16 v[158:159], v179 offset:33792
  s_waitcnt lgkmcnt(6)
  v_mfma_f32_32x32x16_bf16 v[32:47], v[144:147], v[160:163], v[32:47]
  buffer_load_dwordx4 v12, s[8:11], s22 offen offset:2048 lds
  v_mfma_f32_32x32x16_bf16 v[48:63], v[144:147], v[164:167], v[48:63]
  v_mfma_f32_16x16x32_bf16 v[200:203], v[192:195], v[144:147], v[200:203]
  v_mfma_f32_32x32x16_bf16 v[64:79], v[148:151], v[160:163], v[64:79]
  buffer_load_dwordx4 v13, s[8:11], s22 offen offset:3072 lds
  v_mfma_f32_32x32x16_bf16 v[80:95], v[148:151], v[164:167], v[80:95]
  ds_read_b128 v[160:163], v8 offset:16384
  ds_read_b64_tr_b16 v[144:145], v176 offset:40960
  ds_read_b64_tr_b16 v[146:147], v176 offset:41984
  ds_read_b128 v[164:167], v8 offset:20480
  ds_read_b64_tr_b16 v[148:149], v177 offset:40960
  ds_read_b64_tr_b16 v[150:151], v177 offset:41984
  s_waitcnt lgkmcnt(6)
  v_mfma_f32_32x32x16_bf16 v[32:47], v[152:155], v[168:171], v[32:47]
  s_add_u32 m0, s32, 0
  s_add_u32 s22, s22, 229376
  buffer_load_dwordx4 v14, s[4:7], s21 offen offset:0 lds
  v_mfma_f32_32x32x16_bf16 v[48:63], v[152:155], v[172:175], v[48:63]
  v_mfma_f32_16x16x32_bf16 v[200:203], v[196:199], v[156:159], v[200:203]
  v_mfma_f32_32x32x16_bf16 v[64:79], v[156:159], v[168:171], v[64:79]
  buffer_load_dwordx4 v15, s[4:7], s21 offen offset:1024 lds
  s_add_u32 s21, s21, 128
  v_mfma_f32_32x32x16_bf16 v[80:95], v[156:159], v[172:175], v[80:95]
  ds_read_b128 v[168:171], v9 offset:16384
  ds_read_b64_tr_b16 v[152:153], v178 offset:40960
  ds_read_b64_tr_b16 v[154:155], v178 offset:41984
  ds_read_b128 v[172:175], v9 offset:20480
  ds_read_b64_tr_b16 v[156:157], v179 offset:40960
  ds_read_b64_tr_b16 v[158:159], v179 offset:41984
  s_waitcnt lgkmcnt(6)
  v_mfma_f32_32x32x16_bf16 v[32:47], v[144:147], v[160:163], v[32:47]
  v_mfma_f32_32x32x16_bf16 v[48:63], v[144:147], v[164:167], v[48:63]
  v_mfma_f32_16x16x32_bf16 v[200:203], v[192:195], v[144:147], v[200:203]
  v_mfma_f32_32x32x16_bf16 v[64:79], v[148:151], v[160:163], v[64:79]
  v_mfma_f32_32x32x16_bf16 v[80:95], v[148:151], v[164:167], v[80:95]
  s_waitcnt vmcnt(6) lgkmcnt(0)
  s_barrier
  s_load_dwordx2 s[88:89], s[16:17], s61
  ds_read_b128 v[160:163], v6 offset:32768
  ds_read_b64_tr_b16 v[144:145], v180 offset:0
  ds_read_b64_tr_b16 v[146:147], v180 offset:1024
  ds_read_b128 v[164:167], v6 offset:36864
  ds_read_b64_tr_b16 v[148:149], v181 offset:0
  ds_read_b64_tr_b16 v[150:151], v181 offset:1024
  v_mfma_f32_32x32x16_bf16 v[32:47], v[152:155], v[168:171], v[32:47]
  v_mov_b32 v21, s23
  v_mov_b32 v18, s68
  v_mov_b32 v19, s69
  s_mov_b64 exec, 1
  buffer_store_dwordx2 v[18:19], v21, s[16:19], 0 offen sc1
  s_mov_b64 exec, -1
  v_mfma_f32_32x32x16_bf16 v[48:63], v[152:155], v[172:175], v[48:63]
  v_mfma_f32_16x16x32_bf16 v[200:203], v[196:199], v[156:159], v[200:203]
  v_mfma_f32_32x32x16_bf16 v[64:79], v[156:159], v[168:171], v[64:79]
  s_add_u32 m0, s33, 32768
  s_nop 0
  buffer_load_dwordx4 v10, s[8:11], s22 offen offset:0 lds
  v_mfma_f32_32x32x16_bf16 v[80:95], v[156:159], v[172:175], v[80:95]
  ds_read_b128 v[168:171], v7 offset:32768
  ds_read_b64_tr_b16 v[152:153], v182 offset:0
  ds_read_b64_tr_b16 v[154:155], v182 offset:1024
  ds_read_b128 v[172:175], v7 offset:36864
  ds_read_b64_tr_b16 v[156:157], v183 offset:0
  ds_read_b64_tr_b16 v[158:159], v183 offset:1024
  s_waitcnt lgkmcnt(6)
  v_mfma_f32_32x32x16_bf16 v[32:47], v[144:147], v[160:163], v[32:47]
  buffer_load_dwordx4 v11, s[8:11], s22 offen offset:1024 lds
  v_mfma_f32_32x32x16_bf16 v[48:63], v[144:147], v[164:167], v[48:63]
  v_mfma_f32_16x16x32_bf16 v[200:203], v[192:195], v[144:147], v[200:203]
  v_mfma_f32_32x32x16_bf16 v[64:79], v[148:151], v[160:163], v[64:79]
  buffer_load_dwordx4 v12, s[8:11], s22 offen offset:2048 lds
  v_mfma_f32_32x32x16_bf16 v[80:95], v[148:151], v[164:167], v[80:95]
  ds_read_b128 v[160:163], v8 offset:32768
  ds_read_b64_tr_b16 v[144:145], v180 offset:8192
  ds_read_b64_tr_b16 v[146:147], v180 offset:9216
  ds_read_b128 v[164:167], v8 offset:36864
  ds_read_b64_tr_b16 v[148:149], v181 offset:8192
  ds_read_b64_tr_b16 v[150:151], v181 offset:9216
  s_waitcnt lgkmcnt(6)
  v_mfma_f32_32x32x16_bf16 v[32:47], v[152:155], v[168:171], v[32:47]
  buffer_load_dwordx4 v13, s[8:11], s22 offen offset:3072 lds
  v_mfma_f32_32x32x16_bf16 v[48:63], v[152:155], v[172:175], v[48:63]
  v_mfma_f32_16x16x32_bf16 v[200:203], v[196:199], v[156:159], v[200:203]
  v_mfma_f32_32x32x16_bf16 v[64:79], v[156:159], v[168:171], v[64:79]
  s_add_u32 m0, s32, 16384
  s_add_u32 s22, s22, 229376
  buffer_load_dwordx4 v14, s[4:7], s21 offen offset:0 lds
  v_mfma_f32_32x32x16_bf16 v[80:95], v[156:159], v[172:175], v[80:95]
  ds_read_b128 v[168:171], v9 offset:32768
  ds_read_b64_tr_b16 v[152:153], v182 offset:8192
  ds_read_b64_tr_b16 v[154:155], v182 offset:9216
  ds_read_b128 v[172:175], v9 offset:36864
  ds_read_b64_tr_b16 v[156:157], v183 offset:8192
  ds_read_b64_tr_b16 v[158:159], v183 offset:9216
  s_waitcnt lgkmcnt(6)
  v_mfma_f32_32x32x16_bf16 v[32:47], v[144:147], v[160:163], v[32:47]
  buffer_load_dwordx4 v15, s[4:7], s21 offen offset:1024 lds
  s_add_u32 s21, s21, 128
  buffer_load_dwordx4 v[96:99], v27, s[40:43], 0 offen offset:0
  v_mfma_f32_32x32x16_bf16 v[48:63], v[144:147], v[164:167], v[48:63]
  v_mfma_f32_16x16x32_bf16 v[200:203], v[192:195], v[144:147], v[200:203]
  buffer_load_dwordx4 v[100:103], v27, s[40:43], 0 offen offset:4
  buffer_load_dwordx4 v[104:107], v27, s[40:43], 0 offen offset:8
  v_mfma_f32_32x32x16_bf16 v[64:79], v[148:151], v[160:163], v[64:79]
  buffer_load_dwordx4 v[108:111], v27, s[40:43], 0 offen offset:12
  buffer_load_dwordx4 v[112:115], v28, s[40:43], 0 offen
  v_mfma_f32_32x32x16_bf16 v[80:95], v[148:151], v[164:167], v[80:95]
  s_waitcnt vmcnt(12) lgkmcnt(0)
  s_cmp_eq_u64 s[68:69], s[88:89]
  s_cbranch_scc1 K_pa_x
  s_mov_b32 s62, 0x4000
K_pa:
  s_sleep 3
  buffer_load_dwordx2 v[30:31], v243, s[16:19], 0 offen sc1
  s_sub_u32 s62, s62, 1
  s_waitcnt vmcnt(0)
K_pa_c:
  v_cmp_ne_u64 vcc, s[68:69], v[30:31]
  s_cmp_eq_u32 s62, 0
  s_cbranch_scc1 K_pa_y
  s_cmp_lg_u64 vcc, 0
  s_cbranch_scc1 K_pa
K_pa_y:
K_pa_x:
  s_barrier
  ds_read_b128 v[160:163], v6 offset:0
  ds_read_b64_tr_b16 v[144:145], v176 offset:0
  ds_read_b64_tr_b16 v[146:147], v176 offset:1024
  ds_read_b128 v[164:167], v6 offset:4096
  ds_read_b64_tr_b16 v[148:149], v177 offset:0
  ds_read_b64_tr_b16 v[150:151], v177 offset:1024
  v_mfma_f32_32x32x16_bf16 v[32:47], v[152:155], v[168:171], v[32:47]
  buffer_load_dwordx2 v[16:17], v4, s[16:19], s53 offen
  v_mfma_f32_32x32x16_bf16 v[48:63], v[152:155], v[172:175], v[48:63]
  v_mfma_f32_16x16x32_bf16 v[200:203], v[196:199], v[156:159], v[200:203]
  v_mfma_f32_32x32x16_bf16 v[64:79], v[156:159], v[168:171], v[64:79]
  v_mfma_f32_32x32x16_bf16 v[80:95], v[156:159], v[172:175], v[80:95]
  ds_read_b128 v[168:171], v7 offset:0
  ds_read_b64_tr_b16 v[152:153], v178 offset:0
  ds_read_b64_tr_b16 v[154:155], v178 offset:1024
  ds_read_b128 v[172:175], v7 offset:4096
  ds_read_b64_tr_b16 v[156:157], v179 offset:0
  ds_read_b64_tr_b16 v[158:159], v179 offset:1024
  s_waitcnt lgkmcnt(6)
  v_mfma_f32_32x32x16_bf16 v[32:47], v[144:147], v[160:163], v[32:47]
  v_mfma_f32_32x32x16_bf16 v[48:63], v[144:147], v[164:167], v[48:63]
  v_mfma_f32_16x16x32_bf16 v[200:203], v[192:195], v[144:147], v[200:203]
  v_mfma_f32_32x32x16_bf16 v[64:79], v[148:151], v[160:163], v[64:79]
  v_mfma_f32_32x32x16_bf16 v[80:95], v[148:151], v[164:167], v[80:95]
  ds_read_b128 v[160:163], v8 offset:0
  ds_read_b64_tr_b16 v[144:145], v176 offset:8192
  ds_read_b64_tr_b16 v[146:147], v176 offset:9216
  ds_read_b128 v[164:167], v8 offset:4096
  ds_read_b64_tr_b16 v[148:149], v177 offset:8192
  ds_read_b64_tr_b16 v[150:151], v177 offset:9216
  s_waitcnt lgkmcnt(6)
  v_mfma_f32_32x32x16_bf16 v[32:47], v[152:155], v[168:171], v[32:47]
  v_mfma_f32_32x32x16_bf16 v[48:63], v[152:155], v[172:175], v[48:63]
  v_mfma_f32_16x16x32_bf16 v[200:203], v[196:199], v[156:159], v[200:203]
  v_mfma_f32_32x32x16_bf16 v[64:79], v[156:159], v[168:171], v[64:79]
  v_mfma_f32_32x32x16_bf16 v[80:95], v[156:159], v[172:175], v[80:95]
  ds_read_b128 v[168:171], v9 offset:0
  ds_read_b64_tr_b16 v[152:153], v178 offset:8192
  ds_read_b64_tr_b16 v[154:155], v178 offset:9216
  ds_read_b128 v[172:175], v9 offset:4096
  ds_read_b64_tr_b16 v[156:157], v179 offset:8192
  ds_read_b64_tr_b16 v[158:159], v179 offset:9216
  s_waitcnt lgkmcnt(6)
  v_mfma_f32_32x32x16_bf16 v[32:47], v[144:147], v[160:163], v[32:47]
  v_mfma_f32_32x32x16_bf16 v[48:63], v[144:147], v[164:167], v[48:63]
  v_mfma_f32_16x16x32_bf16 v[200:203], v[192:195], v[144:147], v[200:203]
  v_mfma_f32_32x32x16_bf16 v[64:79], v[148:151], v[160:163], v[64:79]
  v_mfma_f32_32x32x16_bf16 v[80:95], v[148:151], v[164:167], v[80:95]
  s_waitcnt vmcnt(1) lgkmcnt(0)
  s_barrier
  ds_read_b128 v[160:163], v6 offset:16384
  ds_read_b64_tr_b16 v[144:145], v176 offset:32768
  ds_read_b64_tr_b16 v[146:147], v176 offset:33792
  ds_read_b128 v[164:167], v6 offset:20480
  ds_read_b64_tr_b16 v[148:149], v177 offset:32768
  ds_read_b64_tr_b16 v[150:151], v177 offset:33792
  v_mfma_f32_32x32x16_bf16 v[32:47], v[152:155], v[168:171], v[32:47]
  v_mov_b32 v132, 0
  v_mov_b32 v133, 0
  v_mov_b32 v134, 0
  v_mov_b32 v135, 0
  s_and_b32 s54, s20, 3
  v_and_b32 v19, 31, v23
  s_mul_i32 s30, s20, 1536
  s_add_u32 s30, s30, 66560
  v_lshl_add_u32 v19, v19, 4, s30
  ds_write_b128 v19, v[132:135]
  buffer_load_dwordx2 v[30:31], v242, s[16:19], 0 offen
  v_mfma_f32_32x32x16_bf16 v[48:63], v[152:155], v[172:175], v[48:63]
  v_mfma_f32_16x16x32_bf16 v[200:203], v[196:199], v[156:159], v[200:203]
  s_mul_i32 s49, s48, 81920
  s_add_u32 s49, s49, 32768
  v_and_b32 v21, 7, v23
  v_mul_u32_u24 v21, 4192, v21
  v_add_u32 v21, s49, v21
  v_lshrrev_b32 v19, 3, v23
  v_min_u32 v19, 2, v19
  v_lshl_add_u32 v19, v19, 4, v21
  ds_write_b128 v19, v[132:135]
  v_mfma_f32_32x32x16_bf16 v[64:79], v[156:159], v[168:171], v[64:79]
  s_add_u32 s30, s49, 64
  v_add_u32 v18, s30, v26
  s_cmp_lg_u32 s54, 0
  s_cbranch_scc1 K_nofix
  s_mov_b64 exec, 1
  v_mov_b32 v96, 0
  v_mov_b32 v97, 0
  v_mov_b32 v98, 0
  v_mov_b32 v99, 0
  v_mov_b32 v100, 0
  v_mov_b32 v101, 0
  v_mov_b32 v102, 0
  v_mov_b32 v103, v112
  v_mov_b32 v104, 0
  v_mov_b32 v105, 0
  v_mov_b32 v106, v112
  v_mov_b32 v107, v113
  v_mov_b32 v108, 0
  v_mov_b32 v109, v112
  v_mov_b32 v110, v113
  v_mov_b32 v111, v114
  s_mov_b64 exec, -1
K_nofix:
  v_mfma_f32_32x32x16_bf16 v[80:95], v[156:159], v[172:175], v[80:95]
  ds_read_b128 v[168:171], v7 offset:16384
  ds_read_b64_tr_b16 v[152:153], v178 offset:32768
  ds_read_b64_tr_b16 v[154:155], v178 offset:33792
  ds_read_b128 v[172:175], v7 offset:20480
  ds_read_b64_tr_b16 v[156:157], v179 offset:32768
  ds_read_b64_tr_b16 v[158:159], v179 offset:33792
  s_waitcnt lgkmcnt(6)
  v_mfma_f32_32x32x16_bf16 v[32:47], v[144:147], v[160:163], v[32:47]
  ds_write_b128 v18, v[100:103] offset:4192
  v_mfma_f32_32x32x16_bf16 v[48:63], v[144:147], v[164:167], v[48:63]
  v_mfma_f32_16x16x32_bf16 v[200:203], v[192:195], v[144:147], v[200:203]
  v_alignbit_b32 v116, v100, v96, 16
  v_alignbit_b32 v117, v101, v97, 16
  v_alignbit_b32 v118, v102, v98, 16
  v_alignbit_b32 v119, v103, v99, 16
  ds_write_b128 v18, v[116:119] offset:0
  v_mfma_f32_32x32x16_bf16 v[64:79], v[148:151], v[160:163], v[64:79]
  ds_write_b128 v18, v[104:107] offset:12576
  v_mfma_f32_32x32x16_bf16 v[80:95], v[148:151], v[164:167], v[80:95]
  ds_read_b128 v[160:163], v8 offset:16384
  ds_read_b64_tr_b16 v[144:145], v176 offset:40960
  ds_read_b64_tr_b16 v[146:147], v176 offset:41984
  ds_read_b128 v[164:167], v8 offset:20480
  ds_read_b64_tr_b16 v[148:149], v177 offset:40960
  ds_read_b64_tr_b16 v[150:151], v177 offset:41984
  s_waitcnt lgkmcnt(6)
  v_mfma_f32_32x32x16_bf16 v[32:47], v[152:155], v[168:171], v[32:47]
  v_alignbit_b32 v120, v104, v100, 16
  v_alignbit_b32 v121, v105, v101, 16
  v_alignbit_b32 v122, v106, v102, 16
  v_alignbit_b32 v123, v107, v103, 16
  ds_write_b128 v18, v[120:123] offset:8384
  v_mfma_f32_32x32x16_bf16 v[48:63], v[152:155], v[172:175], v[48:63]
  v_mfma_f32_16x16x32_bf16 v[200:203], v[196:199], v[156:159], v[200:203]
  ds_write_b128 v18, v[108:111] offset:20960
  v_mfma_f32_32x32x16_bf16 v[64:79], v[156:159], v[168:171], v[64:79]
  v_alignbit_b32 v124, v108, v104, 16
  v_alignbit_b32 v125, v109, v105, 16
  v_alignbit_b32 v126, v110, v106, 16
  v_alignbit_b32 v127, v111, v107, 16
  ds_write_b128 v18, v[124:127] offset:16768
  v_mfma_f32_32x32x16_bf16 v[80:95], v[156:159], v[172:175], v[80:95]
  ds_read_b128 v[168:171], v9 offset:16384
  ds_read_b64_tr_b16 v[152:153], v178 offset:40960
  ds_read_b64_tr_b16 v[154:155], v178 offset:41984
  ds_read_b128 v[172:175], v9 offset:20480
  ds_read_b64_tr_b16 v[156:157], v179 offset:40960
  ds_read_b64_tr_b16 v[158:159], v179 offset:41984
  s_waitcnt lgkmcnt(6)
  v_mfma_f32_32x32x16_bf16 v[32:47], v[144:147], v[160:163], v[32:47]
  ds_write_b128 v18, v[112:115] offset:29344
  v_mfma_f32_32x32x16_bf16 v[48:63], v[144:147], v[164:167], v[48:63]
  v_mfma_f32_16x16x32_bf16 v[200:203], v[192:195], v[144:147], v[200:203]
  v_alignbit_b32 v128, v112, v108, 16
  v_alignbit_b32 v129, v113, v109, 16
  v_alignbit_b32 v130, v114, v110, 16
  v_alignbit_b32 v131, v115, v111, 16
  ds_write_b128 v18, v[128:131] offset:25152
  v_mfma_f32_32x32x16_bf16 v[64:79], v[148:151], v[160:163], v[64:79]
  v_mfma_f32_32x32x16_bf16 v[80:95], v[148:151], v[164:167], v[80:95]
  s_waitcnt lgkmcnt(0)
  v_mfma_f32_16x16x32_bf16 v[200:203], v[196:199], v[156:159], v[200:203]
  v_mfma_f32_32x32x16_bf16 v[32:47], v[152:155], v[168:171], v[32:47]
  v_mfma_f32_32x32x16_bf16 v[48:63], v[152:155], v[172:175], v[48:63]
  s_nop 5
  ds_write_b32 v5, v200
  v_mfma_f32_32x32x16_bf16 v[64:79], v[156:159], v[168:171], v[64:79]
  v_mfma_f32_32x32x16_bf16 v[80:95], v[156:159], v[172:175], v[80:95]
  s_waitcnt vmcnt(0) lgkmcnt(0)
  s_cmp_lg_u32 s20, 0
  s_cbranch_scc1 K_pb_x
  s_mov_b32 s62, 0x4000
  s_branch K_pb_c
K_pb:
  s_sleep 3
  buffer_load_dwordx2 v[30:31], v242, s[16:19], 0 offen sc1
  s_sub_u32 s62, s62, 1
  s_waitcnt vmcnt(0)
K_pb_c:
  v_cmp_ne_u64 vcc, s[68:69], v[30:31]
  s_cmp_eq_u32 s62, 0
  s_cbranch_scc1 K_pb_y
  s_cmp_lg_u64 vcc, 0
  s_cbranch_scc1 K_pb
K_pb_y:
K_pb_x:
  s_barrier
  ds_read_b64 v[20:21], v2
  v_lshrrev_b32 v29, 1, v23
  v_lshlrev_b32 v29, 16, v29
  v_and_b32 v30, 1, v23
  v_lshl_add_u32 v29, v30, 6, v29
  s_lshl_b32 s30, s36, 7
  s_and_b32 s31, s20, 3
  s_lshl_b32 s31, s31, 4
  s_add_u32 s30, s30, s31
  s_add_u32 s30, s30, 10485760
  s_mul_i32 s31, s20, 1536
  s_add_u32 m0, s31, 67072
  v_lshlrev_b32 v3, 4, v23
  buffer_load_dwordx4 v29, s[16:19], s30 offen lds
  s_mul_i32 s30, s20, 28672
  s_mul_i32 s32, s51, 229376
  s_add_u32 s32, s32, s30
  s_add_u32 s32, s32, 8388608
  s_mul_i32 s33, s50, 229376
  s_add_u32 s33, s33, s30
  buffer_load_dwordx4 v[144:147], v3, s[16:19], s32 offen offset:0
  buffer_load_dwordx4 v[148:151], v3, s[16:19], s32 offen offset:1024
  v_mov_b32 v117, 0
  v_mov_b32 v118, 0
  v_mov_b32 v119, 0
  v_mov_b32 v121, 0
  v_mov_b32 v122, 0
  v_mov_b32 v123, 0
  v_mov_b32 v125, 0
  v_mov_b32 v126, 0
  v_mov_b32 v127, 0
  v_mov_b32 v129, 0
  v_mov_b32 v130, 0
  v_mov_b32 v131, 0
  v_cmp_gt_u32 vcc, 32, v23
  v_cvt_pk_bf16_f32 v124, v16, v16
  v_xor_b32 v124, 0x80008000, v124
  v_mov_b32 v128, v124
  v_rcp_f32 v18, v17
  s_waitcnt lgkmcnt(0)
  v_add_f32 v20, v20, v21
  v_permlane32_swap_b32 v124, v128
  v_cvt_pk_bf16_f32 v5, v20, v20
  v_and_b32 v5, 0xffff0000, v5
  v_sub_f32 v22, v20, v5
  v_cvt_pk_bf16_f32 v5, v5, v22
  v_cndmask_b32 v116, 0, v5, vcc
  v_cndmask_b32 v120, v5, v117, vcc
  v_mul_f32 v140, v17, v17
  v_mul_f32 v132, 0xc0135761, v18
  v_mfma_f32_32x32x16_bf16 v[32:47], v[116:119], v[124:127], v[32:47]
  v_mfma_f32_32x32x16_bf16 v[48:63], v[116:119], v[128:131], v[48:63]
  v_mfma_f32_32x32x16_bf16 v[64:79], v[120:123], v[124:127], v[64:79]
  v_mfma_f32_32x32x16_bf16 v[80:95], v[120:123], v[128:131], v[80:95]
  v_mul_f32 v5, v18, v18
  v_mul_f32 v5, v5, v18
  v_mul_f32 v136, 0xbdd2d3e8, v5
  v_mov_b32 v142, v140
  v_mov_b32 v134, v132
  v_mov_b32 v138, v136
  s_nop 0
  v_permlane32_swap_b32 v140, v142
  v_permlane32_swap_b32 v132, v134
  v_permlane32_swap_b32 v136, v138
  s_nop 0
  v_mov_b32 v133, v132
  v_mov_b32 v135, v134
  v_mov_b32 v137, v136
  v_mov_b32 v139, v138
  v_mov_b32 v141, v140
  v_mov_b32 v143, v142
  s_lshr_b32 s30, s20, 1
  s_lshl_b32 s30, s30, 4
  v_and_b32 v24, 15, v23
  v_add_u32 v24, s30, v24
  s_and_b32 s30, s20, 1
  s_lshl_b32 s30, s30, 2
  v_lshrrev_b32 v25, 4, v23
  v_add_u32 v25, s30, v25
  v_lshlrev_b32 v8, 10, v24
  v_lshl_add_u32 v8, v25, 4, v8
  v_lshlrev_b32 v9, 3, v24
  s_lshl_b32 s21, s50, 16
  s_lshl_b32 s30, s51, 7
  s_add_u32 s21, s21, s30
  s_lshl_b32 s22, s50, 9
  s_add_u32 s22, s22, 14680064
  buffer_load_dwordx4 v[12:15], v8, s[4:7], s21 offen
  buffer_load_dwordx2 v[10:11], v9, s[16:19], s22 offen
  s_mov_b64 s[64:65], -1
  v_pk_mul_f32 v[116:117], v[32:33], v[32:33]
  v_pk_mul_f32 v[118:119], v[34:35], v[34:35]
  v_pk_mul_f32 v[120:121], v[36:37], v[36:37]
  v_pk_mul_f32 v[122:123], v[38:39], v[38:39]
  v_pk_fma_f32 v[116:117], v[116:117], v[136:137], v[132:133]
  v_pk_fma_f32 v[118:119], v[118:119], v[136:137], v[132:133]
  v_pk_fma_f32 v[120:121], v[120:121], v[136:137], v[132:133]
  v_pk_fma_f32 v[122:123], v[122:123], v[136:137], v[132:133]
  v_pk_mul_f32 v[116:117], v[116:117], v[32:33]
  v_pk_mul_f32 v[118:119], v[118:119], v[34:35]
  v_pk_mul_f32 v[120:121], v[120:121], v[36:37]
  v_pk_mul_f32 v[122:123], v[122:123], v[38:39]
  v_exp_f32 v116, v116
  v_exp_f32 v117, v117
  v_exp_f32 v118, v118
  v_exp_f32 v119, v119
  v_exp_f32 v120, v120
  v_exp_f32 v121, v121
  v_exp_f32 v122, v122
  v_exp_f32 v123, v123
  v_pk_mul_f32 v[32:33], v[32:33], v[40:41]
  v_pk_mul_f32 v[34:35], v[34:35], v[42:43]
  v_pk_mul_f32 v[36:37], v[36:37], v[44:45]
  v_pk_mul_f32 v[38:39], v[38:39], v[46:47]
  v_pk_fma_f32 v[116:117], v[116:117], v[140:141], v[140:141]
  v_pk_fma_f32 v[118:119], v[118:119], v[140:141], v[140:141]
  v_pk_fma_f32 v[120:121], v[120:121], v[140:141], v[140:141]
  v_pk_fma_f32 v[122:123], v[122:123], v[140:141], v[140:141]
  v_rcp_f32 v116, v116
  v_rcp_f32 v117, v117
  v_rcp_f32 v118, v118
  v_rcp_f32 v119, v119
  v_rcp_f32 v120, v120
  v_rcp_f32 v121, v121
  v_rcp_f32 v122, v122
  v_rcp_f32 v123, v123
  s_nop 0
  v_pk_mul_f32 v[32:33], v[32:33], v[116:117]
  v_pk_mul_f32 v[34:35], v[34:35], v[118:119]
  v_pk_mul_f32 v[36:37], v[36:37], v[120:121]
  v_pk_mul_f32 v[38:39], v[38:39], v[122:123]
  v_cvt_pk_bf16_f32 v40, v32, v33
  v_cvt_pk_bf16_f32 v41, v34, v35
  v_cvt_pk_bf16_f32 v42, v36, v37
  v_cvt_pk_bf16_f32 v43, v38, v39
  s_mov_b64 exec, s[64:65]
  buffer_store_dwordx4 v[40:43], v3, s[16:19], s38 offen offset:0 sc1
  s_mov_b64 exec, -1
  v_pk_mul_f32 v[124:125], v[48:49], v[48:49]
  v_pk_mul_f32 v[126:127], v[50:51], v[50:51]
  v_pk_mul_f32 v[128:129], v[52:53], v[52:53]
  v_pk_mul_f32 v[130:131], v[54:55], v[54:55]
  v_pk_fma_f32 v[124:125], v[124:125], v[138:139], v[134:135]
  v_pk_fma_f32 v[126:127], v[126:127], v[138:139], v[134:135]
  v_pk_fma_f32 v[128:129], v[128:129], v[138:139], v[134:135]
  v_pk_fma_f32 v[130:131], v[130:131], v[138:139], v[134:135]
  v_pk_mul_f32 v[124:125], v[124:125], v[48:49]
  v_pk_mul_f32 v[126:127], v[126:127], v[50:51]
  v_pk_mul_f32 v[128:129], v[128:129], v[52:53]
  v_pk_mul_f32 v[130:131], v[130:131], v[54:55]
  v_exp_f32 v124, v124
  v_exp_f32 v125, v125
  v_exp_f32 v126, v126
  v_exp_f32 v127, v127
  v_exp_f32 v128, v128
  v_exp_f32 v129, v129
  v_exp_f32 v130, v130
  v_exp_f32 v131, v131
  v_pk_mul_f32 v[48:49], v[48:49], v[56:57]
  v_pk_mul_f32 v[50:51], v[50:51], v[58:59]
  v_pk_mul_f32 v[52:53], v[52:53], v[60:61]
  v_pk_mul_f32 v[54:55], v[54:55], v[62:63]
  v_pk_fma_f32 v[124:125], v[124:125], v[142:143], v[142:143]
  v_pk_fma_f32 v[126:127], v[126:127], v[142:143], v[142:143]
  v_pk_fma_f32 v[128:129], v[128:129], v[142:143], v[142:143]
  v_pk_fma_f32 v[130:131], v[130:131], v[142:143], v[142:143]
  v_rcp_f32 v124, v124
  v_rcp_f32 v125, v125
  v_rcp_f32 v126, v126
  v_rcp_f32 v127, v127
  v_rcp_f32 v128, v128
  v_rcp_f32 v129, v129
  v_rcp_f32 v130, v130
  v_rcp_f32 v131, v131
  s_nop 0
  v_pk_mul_f32 v[48:49], v[48:49], v[124:125]
  v_pk_mul_f32 v[50:51], v[50:51], v[126:127]
  v_pk_mul_f32 v[52:53], v[52:53], v[128:129]
  v_pk_mul_f32 v[54:55], v[54:55], v[130:131]
  v_cvt_pk_bf16_f32 v56, v48, v49
  v_cvt_pk_bf16_f32 v57, v50, v51
  v_cvt_pk_bf16_f32 v58, v52, v53
  v_cvt_pk_bf16_f32 v59, v54, v55
  s_mov_b64 exec, s[64:65]
  buffer_store_dwordx4 v[56:59], v3, s[16:19], s38 offen offset:1024 sc1
  s_mov_b64 exec, -1
  v_pk_mul_f32 v[116:117], v[64:65], v[64:65]
  v_pk_mul_f32 v[118:119], v[66:67], v[66:67]
  v_pk_mul_f32 v[120:121], v[68:69], v[68:69]
  v_pk_mul_f32 v[122:123], v[70:71], v[70:71]
  v_pk_fma_f32 v[116:117], v[116:117], v[136:137], v[132:133]
  v_pk_fma_f32 v[118:119], v[118:119], v[136:137], v[132:133]
  v_pk_fma_f32 v[120:121], v[120:121], v[136:137], v[132:133]
  v_pk_fma_f32 v[122:123], v[122:123], v[136:137], v[132:133]
  v_pk_mul_f32 v[116:117], v[116:117], v[64:65]
  v_pk_mul_f32 v[118:119], v[118:119], v[66:67]
  v_pk_mul_f32 v[120:121], v[120:121], v[68:69]
  v_pk_mul_f32 v[122:123], v[122:123], v[70:71]
  v_exp_f32 v116, v116
  v_exp_f32 v117, v117
  v_exp_f32 v118, v118
  v_exp_f32 v119, v119
  v_exp_f32 v120, v120
  v_exp_f32 v121, v121
  v_exp_f32 v122, v122
  v_exp_f32 v123, v123
  v_pk_mul_f32 v[64:65], v[64:65], v[72:73]
  v_pk_mul_f32 v[66:67], v[66:67], v[74:75]
  v_pk_mul_f32 v[68:69], v[68:69], v[76:77]
  v_pk_mul_f32 v[70:71], v[70:71], v[78:79]
  v_pk_fma_f32 v[116:117], v[116:117], v[140:141], v[140:141]
  v_pk_fma_f32 v[118:119], v[118:119], v[140:141], v[140:141]
  v_pk_fma_f32 v[120:121], v[120:121], v[140:141], v[140:141]
  v_pk_fma_f32 v[122:123], v[122:123], v[140:141], v[140:141]
  v_rcp_f32 v116, v116
  v_rcp_f32 v117, v117
  v_rcp_f32 v118, v118
  v_rcp_f32 v119, v119
  v_rcp_f32 v120, v120
  v_rcp_f32 v121, v121
  v_rcp_f32 v122, v122
  v_rcp_f32 v123, v123
  s_nop 0
  v_pk_mul_f32 v[64:65], v[64:65], v[116:117]
  v_pk_mul_f32 v[66:67], v[66:67], v[118:119]
  v_pk_mul_f32 v[68:69], v[68:69], v[120:121]
  v_pk_mul_f32 v[70:71], v[70:71], v[122:123]
  v_cvt_pk_bf16_f32 v72, v64, v65
  v_cvt_pk_bf16_f32 v73, v66, v67
  v_cvt_pk_bf16_f32 v74, v68, v69
  v_cvt_pk_bf16_f32 v75, v70, v71
  s_mov_b64 exec, s[64:65]
  buffer_store_dwordx4 v[72:75], v3, s[16:19], s38 offen offset:2048 sc1
  s_mov_b64 exec, -1
  v_pk_mul_f32 v[124:125], v[80:81], v[80:81]
  v_pk_mul_f32 v[126:127], v[82:83], v[82:83]
  v_pk_mul_f32 v[128:129], v[84:85], v[84:85]
  v_pk_mul_f32 v[130:131], v[86:87], v[86:87]
  v_pk_fma_f32 v[124:125], v[124:125], v[138:139], v[134:135]
  v_pk_fma_f32 v[126:127], v[126:127], v[138:139], v[134:135]
  v_pk_fma_f32 v[128:129], v[128:129], v[138:139], v[134:135]
  v_pk_fma_f32 v[130:131], v[130:131], v[138:139], v[134:135]
  v_pk_mul_f32 v[124:125], v[124:125], v[80:81]
  v_pk_mul_f32 v[126:127], v[126:127], v[82:83]
  v_pk_mul_f32 v[128:129], v[128:129], v[84:85]
  v_pk_mul_f32 v[130:131], v[130:131], v[86:87]
  v_exp_f32 v124, v124
  v_exp_f32 v125, v125
  v_exp_f32 v126, v126
  v_exp_f32 v127, v127
  v_exp_f32 v128, v128
  v_exp_f32 v129, v129
  v_exp_f32 v130, v130
  v_exp_f32 v131, v131
  v_pk_mul_f32 v[80:81], v[80:81], v[88:89]
  v_pk_mul_f32 v[82:83], v[82:83], v[90:91]
  v_pk_mul_f32 v[84:85], v[84:85], v[92:93]
  v_pk_mul_f32 v[86:87], v[86:87], v[94:95]
  v_pk_fma_f32 v[124:125], v[124:125], v[142:143], v[142:143]
  v_pk_fma_f32 v[126:127], v[126:127], v[142:143], v[142:143]
  v_pk_fma_f32 v[128:129], v[128:129], v[142:143], v[142:143]
  v_pk_fma_f32 v[130:131], v[130:131], v[142:143], v[142:143]
  v_rcp_f32 v124, v124
  v_rcp_f32 v125, v125
  v_rcp_f32 v126, v126
  v_rcp_f32 v127, v127
  v_rcp_f32 v128, v128
  v_rcp_f32 v129, v129
  v_rcp_f32 v130, v130
  v_rcp_f32 v131, v131
  s_nop 0
  v_pk_mul_f32 v[80:81], v[80:81], v[124:125]
  v_pk_mul_f32 v[82:83], v[82:83], v[126:127]
  v_pk_mul_f32 v[84:85], v[84:85], v[128:129]
  v_pk_mul_f32 v[86:87], v[86:87], v[130:131]
  v_cvt_pk_bf16_f32 v88, v80, v81
  v_cvt_pk_bf16_f32 v89, v82, v83
  v_cvt_pk_bf16_f32 v90, v84, v85
  v_cvt_pk_bf16_f32 v91, v86, v87
  s_mov_b64 exec, s[64:65]
  buffer_store_dwordx4 v[88:91], v3, s[16:19], s38 offen offset:3072 sc1
  s_mov_b64 exec, -1
K_p2b:
  s_setprio 2
  s_and_b32 s34, s20, 1
  s_bfe_u32 s35, s20, 0x10001
  v_lshrrev_b32 v27, 5, v23
  v_and_b32 v30, 31, v23
  v_and_b32 v31, 7, v23
  v_mul_u32_u24 v31, 4192, v31
  v_add_u32 v31, s49, v31
  v_bfe_u32 v17, v23, 3, 2
  v_sub_u32 v17, v17, v27
  s_lshl_b32 s30, s34, 1
  s_sub_u32 s30, 3, s30
  s_lshl_b32 s31, s35, 6
  s_add_u32 s30, s30, s31
  v_add_u32 v17, s30, v17
  v_lshl_add_u32 v17, v17, 4, v31
  s_mul_i32 s55, s48, 6144
  s_add_u32 s55, s55, 66560
  s_mul_i32 s30, s34, 3072
  s_add_u32 s55, s55, s30
  s_lshl_b32 s31, s35, 8
  s_sub_u32 s30, s55, s31
  v_mul_u32_u24 v16, 1536, v27
  v_lshl_add_u32 v16, v30, 4, v16
  v_add_u32 v16, s30, v16
  s_sub_u32 s30, s49, 32768
  v_add_u32 v22, s30, v3
  s_lshl_b32 s31, s54, 11
  v_add_u32 v21, s31, v22
  s_lshl_b32 s31, s54, 13
  v_add_u32 v22, s31, v22
  v_lshlrev_b32 v26, 4, v30
  v_lshlrev_b32 v31, 3, v27
  v_sub_u32 v26, v26, v31
  s_lshl_b32 s30, s35, 9
  s_add_u32 s30, s30, s55
  s_add_u32 s30, s30, 520
  v_add_u32 v26, s30, v26
  s_lshr_b32 s30, s20, 1
  s_lshl_b32 s30, s30, 11
  s_lshl_b32 s31, s34, 5
  s_add_u32 s30, s30, s31
  s_add_u32 s30, s30, 144384
  v_lshl_add_u32 v19, v30, 6, v31
  v_add_u32 v19, s30, v19
  v_min_u32 v29, 6, v23
  s_mul_i32 s60, s50, 56
  s_mul_i32 s30, s20, 7
  s_add_u32 s60, s60, s30
  s_lshl_b32 s60, s60, 7
  s_add_u32 s60, s60, 14811136
  v_lshl_add_u32 v29, v29, 7, s60
  v_mov_b32 v0, s68
  v_mov_b32 v1, s69
  v_mov_b32 v2, v30
  s_lshl_b32 s30, s37, 16
  s_and_b32 s31, s37, 0xffff0000
  s_cmp_eq_u32 s48, 0
  s_cselect_b32 s37, s30, s31
  s_waitcnt vmcnt(8) lgkmcnt(0)
  s_barrier
  ds_read_b128 v[224:227], v17 offset:0
  ds_read_b128 v[232:235], v16 offset:512
  ds_read_b128 v[228:231], v17 offset:2048
  ds_read_b128 v[236:239], v16 offset:1024
  ds_read_b128 v[240:243], v17 offset:64
  ds_read_b128 v[248:251], v16 offset:496
  ds_read_b128 v[244:247], v17 offset:2112
  ds_read_b128 v[252:255], v16 offset:1008
  s_waitcnt lgkmcnt(4)
  v_mfma_f32_32x32x16_bf16 v[192:207], v[224:227], v[232:235], 0
  v_mfma_f32_32x32x16_bf16 v[208:223], v[228:231], v[232:235], 0
  v_mfma_f32_32x32x16_bf16 v[208:223], v[224:227], v[236:239], v[208:223]
  s_cmp_eq_u32 s52, 0
  s_cbranch_scc1 K_nf
  s_waitcnt vmcnt(0)
  s_mov_b64 exec, 1
  buffer_store_dwordx2 v[0:1], off, s[16:19], s52 sc1
  s_mov_b64 exec, -1
K_nf:
  s_setprio 0
  buffer_load_dwordx4 v[152:155], v3, s[16:19], s32 offen offset:2048
  buffer_load_dwordx4 v[156:159], v3, s[16:19], s32 offen offset:3072
  s_add_u32 s32, s32, 4096
  ds_read_b128 v[224:227], v17 offset:128
  ds_read_b128 v[232:235], v16 offset:480
  ds_read_b128 v[228:231], v17 offset:2176
  ds_read_b128 v[236:239], v16 offset:992
  s_waitcnt lgkmcnt(4)
  v_mfma_f32_32x32x16_bf16 v[192:207], v[240:243], v[248:251], v[192:207]
  v_mfma_f32_32x32x16_bf16 v[208:223], v[244:247], v[248:251], v[208:223]
  v_mfma_f32_32x32x16_bf16 v[208:223], v[240:243], v[252:255], v[208:223]
  buffer_load_dwordx4 v[160:163], v3, s[16:19], s32 offen offset:0
  buffer_load_dwordx4 v[164:167], v3, s[16:19], s32 offen offset:1024
  ds_read_b128 v[240:243], v17 offset:192
  ds_read_b128 v[248:251], v16 offset:464
  ds_read_b128 v[244:247], v17 offset:2240
  ds_read_b128 v[252:255], v16 offset:976
  s_waitcnt lgkmcnt(4)
  v_mfma_f32_32x32x16_bf16 v[192:207], v[224:227], v[232:235], v[192:207]
  v_mfma_f32_32x32x16_bf16 v[208:223], v[228:231], v[232:235], v[208:223]
  v_mfma_f32_32x32x16_bf16 v[208:223], v[224:227], v[236:239], v[208:223]
  buffer_load_dwordx4 v[168:171], v3, s[16:19], s32 offen offset:2048
  buffer_load_dwordx4 v[172:175], v3, s[16:19], s32 offen offset:3072
  s_add_u32 s32, s32, 4096
  ds_read_b128 v[224:227], v17 offset:256
  ds_read_b128 v[232:235], v16 offset:448
  ds_read_b128 v[228:231], v17 offset:2304
  ds_read_b128 v[236:239], v16 offset:960
  s_waitcnt lgkmcnt(4)
  v_mfma_f32_32x32x16_bf16 v[192:207], v[240:243], v[248:251], v[192:207]
  v_mfma_f32_32x32x16_bf16 v[208:223], v[244:247], v[248:251], v[208:223]
  v_mfma_f32_32x32x16_bf16 v[208:223], v[240:243], v[252:255], v[208:223]
  buffer_load_dwordx4 v[176:179], v3, s[16:19], s32 offen offset:0
  buffer_load_dwordx4 v[180:183], v3, s[16:19], s32 offen offset:1024
  ds_read_b128 v[240:243], v17 offset:320
  ds_read_b128 v[248:251], v16 offset:432
  ds_read_b128 v[244:247], v17 offset:2368
  ds_read_b128 v[252:255], v16 offset:944
  s_waitcnt lgkmcnt(4)
  v_mfma_f32_32x32x16_bf16 v[192:207], v[224:227], v[232:235], v[192:207]
  v_mfma_f32_32x32x16_bf16 v[208:223], v[228:231], v[232:235], v[208:223]
  v_mfma_f32_32x32x16_bf16 v[208:223], v[224:227], v[236:239], v[208:223]
  buffer_load_dwordx4 v[184:187], v3, s[16:19], s32 offen offset:2048
  buffer_load_dwordx4 v[188:191], v3, s[16:19], s32 offen offset:3072
  s_add_u32 s32, s32, 4096
  ds_read_b128 v[224:227], v17 offset:384
  ds_read_b128 v[232:235], v16 offset:416
  ds_read_b128 v[228:231], v17 offset:2432
  ds_read_b128 v[236:239], v16 offset:928
  s_waitcnt lgkmcnt(4)
  v_mfma_f32_32x32x16_bf16 v[192:207], v[240:243], v[248:251], v[192:207]
  v_mfma_f32_32x32x16_bf16 v[208:223], v[244:247], v[248:251], v[208:223]
  v_mfma_f32_32x32x16_bf16 v[208:223], v[240:243], v[252:255], v[208:223]
  buffer_load_dwordx4 v[32:35], v3, s[16:19], s32 offen offset:0
  buffer_load_dwordx4 v[36:39], v3, s[16:19], s32 offen offset:1024
  ds_read_b128 v[240:243], v17 offset:448
  ds_read_b128 v[248:251], v16 offset:400
  ds_read_b128 v[244:247], v17 offset:2496
  ds_read_b128 v[252:255], v16 offset:912
  s_waitcnt lgkmcnt(4)
  v_mfma_f32_32x32x16_bf16 v[192:207], v[224:227], v[232:235], v[192:207]
  v_mfma_f32_32x32x16_bf16 v[208:223], v[228:231], v[232:235], v[208:223]
  v_mfma_f32_32x32x16_bf16 v[208:223], v[224:227], v[236:239], v[208:223]
  buffer_load_dwordx4 v[40:43], v3, s[16:19], s32 offen offset:2048
  buffer_load_dwordx4 v[44:47], v3, s[16:19], s32 offen offset:3072
  s_add_u32 s32, s32, 4096
  ds_read_b128 v[224:227], v17 offset:512
  ds_read_b128 v[232:235], v16 offset:384
  ds_read_b128 v[228:231], v17 offset:2560
  ds_read_b128 v[236:239], v16 offset:896
  s_waitcnt lgkmcnt(4)
  v_mfma_f32_32x32x16_bf16 v[192:207], v[240:243], v[248:251], v[192:207]
  v_mfma_f32_32x32x16_bf16 v[208:223], v[244:247], v[248:251], v[208:223]
  v_mfma_f32_32x32x16_bf16 v[208:223], v[240:243], v[252:255], v[208:223]
  buffer_load_dwordx4 v[48:51], v3, s[16:19], s32 offen offset:0
  buffer_load_dwordx4 v[52:55], v3, s[16:19], s32 offen offset:1024
  ds_read_b128 v[240:243], v17 offset:576
  ds_read_b128 v[248:251], v16 offset:368
  ds_read_b128 v[244:247], v17 offset:2624
  ds_read_b128 v[252:255], v16 offset:880
  s_waitcnt lgkmcnt(4)
  v_mfma_f32_32x32x16_bf16 v[192:207], v[224:227], v[232:235], v[192:207]
  v_mfma_f32_32x32x16_bf16 v[208:223], v[228:231], v[232:235], v[208:223]
  v_mfma_f32_32x32x16_bf16 v[208:223], v[224:227], v[236:239], v[208:223]
  buffer_load_dwordx4 v[56:59], v3, s[16:19], s32 offen offset:2048
  buffer_load_dwordx4 v[60:63], v3, s[16:19], s32 offen offset:3072
  s_add_u32 s32, s32, 4096
  ds_read_b128 v[224:227], v17 offset:640
  ds_read_b128 v[232:235], v16 offset:352
  ds_read_b128 v[228:231], v17 offset:2688
  ds_read_b128 v[236:239], v16 offset:864
  s_waitcnt lgkmcnt(4)
  v_mfma_f32_32x32x16_bf16 v[192:207], v[240:243], v[248:251], v[192:207]
  v_mfma_f32_32x32x16_bf16 v[208:223], v[244:247], v[248:251], v[208:223]
  v_mfma_f32_32x32x16_bf16 v[208:223], v[240:243], v[252:255], v[208:223]
  buffer_load_dwordx4 v[64:67], v3, s[16:19], s32 offen offset:0
  buffer_load_dwordx4 v[68:71], v3, s[16:19], s32 offen offset:1024
  ds_read_b128 v[240:243], v17 offset:704
  ds_read_b128 v[248:251], v16 offset:336
  ds_read_b128 v[244:247], v17 offset:2752
  ds_read_b128 v[252:255], v16 offset:848
  s_waitcnt lgkmcnt(4)
  v_mfma_f32_32x32x16_bf16 v[192:207], v[224:227], v[232:235], v[192:207]
  v_mfma_f32_32x32x16_bf16 v[208:223], v[228:231], v[232:235], v[208:223]
  v_mfma_f32_32x32x16_bf16 v[208:223], v[224:227], v[236:239], v[208:223]
  buffer_load_dwordx4 v[72:75], v3, s[16:19], s32 offen offset:2048
  buffer_load_dwordx4 v[76:79], v3, s[16:19], s32 offen offset:3072
  s_add_u32 s32, s32, 4096
  ds_read_b128 v[224:227], v17 offset:768
  ds_read_b128 v[232:235], v16 offset:320
  ds_read_b128 v[228:231], v17 offset:2816
  ds_read_b128 v[236:239], v16 offset:832
  s_waitcnt lgkmcnt(4)
  v_mfma_f32_32x32x16_bf16 v[192:207], v[240:243], v[248:251], v[192:207]
  v_mfma_f32_32x32x16_bf16 v[208:223], v[244:247], v[248:251], v[208:223]
  v_mfma_f32_32x32x16_bf16 v[208:223], v[240:243], v[252:255], v[208:223]
  buffer_load_dwordx4 v[80:83], v3, s[16:19], s32 offen offset:0
  buffer_load_dwordx4 v[84:87], v3, s[16:19], s32 offen offset:1024
  ds_read_b128 v[240:243], v17 offset:832
  ds_read_b128 v[248:251], v16 offset:304
  ds_read_b128 v[244:247], v17 offset:2880
  ds_read_b128 v[252:255], v16 offset:816
  s_waitcnt lgkmcnt(4)
  v_mfma_f32_32x32x16_bf16 v[192:207], v[224:227], v[232:235], v[192:207]
  v_mfma_f32_32x32x16_bf16 v[208:223], v[228:231], v[232:235], v[208:223]
  v_mfma_f32_32x32x16_bf16 v[208:223], v[224:227], v[236:239], v[208:223]
  buffer_load_dwordx4 v[88:91], v3, s[16:19], s32 offen offset:2048
  buffer_load_dwordx4 v[92:95], v3, s[16:19], s32 offen offset:3072
  s_add_u32 s32, s32, 4096
  ds_read_b128 v[224:227], v17 offset:896
  ds_read_b128 v[232:235], v16 offset:288
  ds_read_b128 v[228:231], v17 offset:2944
  ds_read_b128 v[236:239], v16 offset:800
  s_waitcnt lgkmcnt(4)
  v_mfma_f32_32x32x16_bf16 v[192:207], v[240:243], v[248:251], v[192:207]
  v_mfma_f32_32x32x16_bf16 v[208:223], v[244:247], v[248:251], v[208:223]
  v_mfma_f32_32x32x16_bf16 v[208:223], v[240:243], v[252:255], v[208:223]
  ds_read_b128 v[240:243], v17 offset:960
  ds_read_b128 v[248:251], v16 offset:272
  ds_read_b128 v[244:247], v17 offset:3008
  ds_read_b128 v[252:255], v16 offset:784
  s_waitcnt lgkmcnt(4)
  v_mfma_f32_32x32x16_bf16 v[192:207], v[224:227], v[232:235], v[192:207]
  v_mfma_f32_32x32x16_bf16 v[208:223], v[228:231], v[232:235], v[208:223]
  v_mfma_f32_32x32x16_bf16 v[208:223], v[224:227], v[236:239], v[208:223]
  buffer_load_dwordx2 v[30:31], v29, s[16:19], 0 offen
  ds_read_b64 v[4:5], v26
  ds_read_b64 v[6:7], v26 offset:1536
  s_waitcnt lgkmcnt(2)
  v_mfma_f32_32x32x16_bf16 v[192:207], v[240:243], v[248:251], v[192:207]
  v_mfma_f32_32x32x16_bf16 v[208:223], v[244:247], v[248:251], v[208:223]
  v_mfma_f32_32x32x16_bf16 v[208:223], v[240:243], v[252:255], v[208:223]
  v_lshrrev_b32 v28, 3, v23
  v_lshlrev_b32 v28, 16, v28
  v_and_b32 v18, 7, v23
  v_lshl_add_u32 v28, v18, 4, v28
  s_lshl_b32 s61, s54, 19
  s_lshl_b32 s30, s36, 7
  s_add_u32 s61, s61, s30
  s_add_u32 s61, s61, 12582912
  s_nop 3
  s_mov_b32 s63, 0
  ds_write_b128 v21, v[192:195] offset:0
  ds_write_b128 v21, v[196:199] offset:1024
  ds_write_b128 v21, v[200:203] offset:8192
  ds_write_b128 v21, v[204:207] offset:9216
  ds_write_b128 v21, v[208:211] offset:16384
  ds_write_b128 v21, v[212:215] offset:17408
  ds_write_b128 v21, v[216:219] offset:24576
  ds_write_b128 v21, v[220:223] offset:25600
  s_waitcnt vmcnt(0)
  v_cmp_ne_u64 vcc, s[68:69], v[30:31]
  s_cmp_lg_u64 vcc, 0
  s_cbranch_scc1 K_t1
  s_mov_b32 s63, 1
  buffer_load_dwordx4 v[96:99], v3, s[16:19], s33 offen offset:0
  buffer_load_dwordx4 v[100:103], v3, s[16:19], s33 offen offset:1024
  buffer_load_dwordx4 v[104:107], v3, s[16:19], s33 offen offset:2048
  buffer_load_dwordx4 v[108:111], v3, s[16:19], s33 offen offset:3072
  s_add_u32 s33, s33, 4096
  buffer_load_dwordx4 v[112:115], v3, s[16:19], s33 offen offset:0
  buffer_load_dwordx4 v[116:119], v3, s[16:19], s33 offen offset:1024
  buffer_load_dwordx4 v[120:123], v3, s[16:19], s33 offen offset:2048
  buffer_load_dwordx4 v[124:127], v3, s[16:19], s33 offen offset:3072
  s_add_u32 s33, s33, 4096
  buffer_load_dwordx4 v[128:131], v3, s[16:19], s33 offen offset:0
  buffer_load_dwordx4 v[132:135], v3, s[16:19], s33 offen offset:1024
  buffer_load_dwordx4 v[136:139], v3, s[16:19], s33 offen offset:2048
  buffer_load_dwordx4 v[140:143], v3, s[16:19], s33 offen offset:3072
  s_add_u32 s33, s33, 4096
  s_branch K_t1_x
K_t1:
  buffer_load_dwordx2 v[30:31], v29, s[16:19], 0 offen sc1
K_t1_x:
  s_waitcnt lgkmcnt(0)
  s_barrier
  ds_read_b128 v[224:227], v22 offset:0
  ds_read_b128 v[228:231], v22 offset:1024
  ds_read_b128 v[232:235], v22 offset:2048
  ds_read_b128 v[236:239], v22 offset:3072
  ds_read_b128 v[240:243], v22 offset:4096
  ds_read_b128 v[244:247], v22 offset:5120
  ds_read_b128 v[248:251], v22 offset:6144
  ds_read_b128 v[252:255], v22 offset:7168
  s_cmp_lg_u32 s63, 0
  s_cbranch_scc1 K_t2_x
  s_waitcnt vmcnt(0)
  v_cmp_ne_u64 vcc, s[68:69], v[30:31]
  s_cmp_lg_u64 vcc, 0
  s_cbranch_scc1 K_t2
  s_mov_b32 s63, 1
  buffer_load_dwordx4 v[96:99], v3, s[16:19], s33 offen offset:0
  buffer_load_dwordx4 v[100:103], v3, s[16:19], s33 offen offset:1024
  buffer_load_dwordx4 v[104:107], v3, s[16:19], s33 offen offset:2048
  buffer_load_dwordx4 v[108:111], v3, s[16:19], s33 offen offset:3072
  s_add_u32 s33, s33, 4096
  buffer_load_dwordx4 v[112:115], v3, s[16:19], s33 offen offset:0
  buffer_load_dwordx4 v[116:119], v3, s[16:19], s33 offen offset:1024
  buffer_load_dwordx4 v[120:123], v3, s[16:19], s33 offen offset:2048
  buffer_load_dwordx4 v[124:127], v3, s[16:19], s33 offen offset:3072
  s_add_u32 s33, s33, 4096
  buffer_load_dwordx4 v[128:131], v3, s[16:19], s33 offen offset:0
  buffer_load_dwordx4 v[132:135], v3, s[16:19], s33 offen offset:1024
  buffer_load_dwordx4 v[136:139], v3, s[16:19], s33 offen offset:2048
  buffer_load_dwordx4 v[140:143], v3, s[16:19], s33 offen offset:3072
  s_add_u32 s33, s33, 4096
  s_branch K_t2_x
K_t2:
  buffer_load_dwordx2 v[30:31], v29, s[16:19], 0 offen sc1
K_t2_x:
  v_and_b32 v192, 0xffff0000, v5
  v_lshlrev_b32 v193, 16, v5
  v_and_b32 v194, 0xffff0000, v4
  v_lshlrev_b32 v195, 16, v4
  v_and_b32 v196, 0xffff0000, v7
  v_lshlrev_b32 v197, 16, v7
  v_and_b32 v198, 0xffff0000, v6
  v_lshlrev_b32 v199, 16, v6
  s_waitcnt lgkmcnt(0)
  v_fma_f32 v192, s37, v192, v224
  v_fma_f32 v193, s37, v193, v225
  v_fma_f32 v194, s37, v194, v226
  v_fma_f32 v195, s37, v195, v227
  v_fma_f32 v196, s37, v196, v228
  v_fma_f32 v197, s37, v197, v229
  v_fma_f32 v198, s37, v198, v230
  v_fma_f32 v199, s37, v199, v231
  v_pk_add_f32 v[232:233], v[232:233], v[240:241]
  v_pk_add_f32 v[192:193], v[192:193], v[248:249]
  v_pk_add_f32 v[234:235], v[234:235], v[242:243]
  v_pk_add_f32 v[194:195], v[194:195], v[250:251]
  v_pk_add_f32 v[236:237], v[236:237], v[244:245]
  v_pk_add_f32 v[196:197], v[196:197], v[252:253]
  v_pk_add_f32 v[238:239], v[238:239], v[246:247]
  v_pk_add_f32 v[198:199], v[198:199], v[254:255]
  v_pk_add_f32 v[192:193], v[192:193], v[232:233]
  v_pk_add_f32 v[194:195], v[194:195], v[234:235]
  v_pk_add_f32 v[196:197], v[196:197], v[236:237]
  v_pk_add_f32 v[198:199], v[198:199], v[238:239]
  v_cvt_pk_bf16_f32 v4, v192, v193
  v_cvt_pk_bf16_f32 v5, v194, v195
  v_cvt_pk_bf16_f32 v6, v196, v197
  v_cvt_pk_bf16_f32 v7, v198, v199
  ds_write_b64 v19, v[4:5]
  ds_write_b64 v19, v[6:7] offset:16
  s_lshl_b32 s30, s20, 10
  s_add_u32 s30, s30, 144384
  v_add_u32 v18, s30, v3
  s_waitcnt lgkmcnt(0)
  s_barrier
  ds_read_b128 v[4:7], v18
  v_and_b32 v26, 15, v23
  v_xor_b32 v26, v26, v27
  s_lshl_b32 s30, s20, 14
  v_lshl_add_u32 v17, v2, 8, s30
  v_lshl_add_u32 v16, v26, 4, v17
  s_lshl_b32 s60, s50, 16
  s_lshl_b32 s31, s51, 13
  s_add_u32 s60, s60, s31
  s_lshl_b32 s31, s20, 10
  s_add_u32 s60, s60, s31
  s_add_u32 s60, s60, 12582912
  s_cmp_lg_u32 s63, 0
  s_cbranch_scc1 K_t3
  s_waitcnt vmcnt(0)
  v_cmp_ne_u64 vcc, s[68:69], v[30:31]
  s_cmp_lg_u64 vcc, 0
  s_cbranch_scc1 K_t3
  s_mov_b32 s63, 1
  buffer_load_dwordx4 v[96:99], v3, s[16:19], s33 offen offset:0
  buffer_load_dwordx4 v[100:103], v3, s[16:19], s33 offen offset:1024
  buffer_load_dwordx4 v[104:107], v3, s[16:19], s33 offen offset:2048
  buffer_load_dwordx4 v[108:111], v3, s[16:19], s33 offen offset:3072
  s_add_u32 s33, s33, 4096
  buffer_load_dwordx4 v[112:115], v3, s[16:19], s33 offen offset:0
  buffer_load_dwordx4 v[116:119], v3, s[16:19], s33 offen offset:1024
  buffer_load_dwordx4 v[120:123], v3, s[16:19], s33 offen offset:2048
  buffer_load_dwordx4 v[124:127], v3, s[16:19], s33 offen offset:3072
  s_add_u32 s33, s33, 4096
  buffer_load_dwordx4 v[128:131], v3, s[16:19], s33 offen offset:0
  buffer_load_dwordx4 v[132:135], v3, s[16:19], s33 offen offset:1024
  buffer_load_dwordx4 v[136:139], v3, s[16:19], s33 offen offset:2048
  buffer_load_dwordx4 v[140:143], v3, s[16:19], s33 offen offset:3072
  s_add_u32 s33, s33, 4096
K_t3:
  s_waitcnt lgkmcnt(0)
  buffer_store_dwordx4 v[4:7], v28, s[16:19], s61 offen sc1
  s_cmp_lg_u32 s63, 0
  s_cbranch_scc1 K_g2
  s_mov_b32 s62, 0x4000
K_hp:
  s_sleep 3
  buffer_load_dwordx2 v[30:31], v29, s[16:19], 0 offen sc1
  s_sub_u32 s62, s62, 1
  s_waitcnt vmcnt(0)
K_hp_c:
  v_cmp_ne_u64 vcc, s[68:69], v[30:31]
  s_cmp_eq_u32 s62, 0
  s_cbranch_scc1 K_hp_y
  s_cmp_lg_u64 vcc, 0
  s_cbranch_scc1 K_hp
K_hp_y:
K_hp_x:
  buffer_load_dwordx4 v[96:99], v3, s[16:19], s33 offen offset:0
  buffer_load_dwordx4 v[100:103], v3, s[16:19], s33 offen offset:1024
  buffer_load_dwordx4 v[104:107], v3, s[16:19], s33 offen offset:2048
  buffer_load_dwordx4 v[108:111], v3, s[16:19], s33 offen offset:3072
  s_add_u32 s33, s33, 4096
  buffer_load_dwordx4 v[112:115], v3, s[16:19], s33 offen offset:0
  buffer_load_dwordx4 v[116:119], v3, s[16:19], s33 offen offset:1024
  buffer_load_dwordx4 v[120:123], v3, s[16:19], s33 offen offset:2048
  buffer_load_dwordx4 v[124:127], v3, s[16:19], s33 offen offset:3072
  s_add_u32 s33, s33, 4096
  buffer_load_dwordx4 v[128:131], v3, s[16:19], s33 offen offset:0
  buffer_load_dwordx4 v[132:135], v3, s[16:19], s33 offen offset:1024
  buffer_load_dwordx4 v[136:139], v3, s[16:19], s33 offen offset:2048
  buffer_load_dwordx4 v[140:143], v3, s[16:19], s33 offen offset:3072
  s_add_u32 s33, s33, 4096
K_g2:
  s_waitcnt vmcnt(10)
  v_mfma_f32_32x32x16_bf16 v[192:207], v[144:147], v[96:99], 0
  v_mfma_f32_32x32x16_bf16 v[224:239], v[148:151], v[96:99], 0
  v_mfma_f32_32x32x16_bf16 v[240:255], v[148:151], v[100:103], 0
  v_mfma_f32_32x32x16_bf16 v[208:223], v[144:147], v[100:103], 0
  buffer_load_dwordx4 v[96:99], v3, s[16:19], s33 offen offset:0
  buffer_load_dwordx4 v[100:103], v3, s[16:19], s33 offen offset:1024
  s_waitcnt vmcnt(10)
  v_mfma_f32_32x32x16_bf16 v[192:207], v[152:155], v[104:107], v[192:207]
  v_mfma_f32_32x32x16_bf16 v[224:239], v[156:159], v[104:107], v[224:239]
  v_mfma_f32_32x32x16_bf16 v[240:255], v[156:159], v[108:111], v[240:255]
  v_mfma_f32_32x32x16_bf16 v[208:223], v[152:155], v[108:111], v[208:223]
  buffer_load_dwordx4 v[104:107], v3, s[16:19], s33 offen offset:2048
  buffer_load_dwordx4 v[108:111], v3, s[16:19], s33 offen offset:3072
  s_add_u32 s33, s33, 4096
  s_waitcnt vmcnt(10)
  v_mfma_f32_32x32x16_bf16 v[192:207], v[160:163], v[112:115], v[192:207]
  v_mfma_f32_32x32x16_bf16 v[224:239], v[164:167], v[112:115], v[224:239]
  v_mfma_f32_32x32x16_bf16 v[240:255], v[164:167], v[116:119], v[240:255]
  v_mfma_f32_32x32x16_bf16 v[208:223], v[160:163], v[116:119], v[208:223]
  buffer_load_dwordx4 v[112:115], v3, s[16:19], s33 offen offset:0
  buffer_load_dwordx4 v[116:119], v3, s[16:19], s33 offen offset:1024
  s_waitcnt vmcnt(10)
  v_mfma_f32_32x32x16_bf16 v[192:207], v[168:171], v[120:123], v[192:207]
  v_mfma_f32_32x32x16_bf16 v[224:239], v[172:175], v[120:123], v[224:239]
  v_mfma_f32_32x32x16_bf16 v[240:255], v[172:175], v[124:127], v[240:255]
  v_mfma_f32_32x32x16_bf16 v[208:223], v[168:171], v[124:127], v[208:223]
  buffer_load_dwordx4 v[120:123], v3, s[16:19], s33 offen offset:2048
  buffer_load_dwordx4 v[124:127], v3, s[16:19], s33 offen offset:3072
  s_add_u32 s33, s33, 4096
  s_waitcnt vmcnt(10)
  v_mfma_f32_32x32x16_bf16 v[192:207], v[176:179], v[128:131], v[192:207]
  v_mfma_f32_32x32x16_bf16 v[224:239], v[180:183], v[128:131], v[224:239]
  v_mfma_f32_32x32x16_bf16 v[240:255], v[180:183], v[132:135], v[240:255]
  v_mfma_f32_32x32x16_bf16 v[208:223], v[176:179], v[132:135], v[208:223]
  buffer_load_dwordx4 v[128:131], v3, s[16:19], s33 offen offset:0
  buffer_load_dwordx4 v[132:135], v3, s[16:19], s33 offen offset:1024
  s_waitcnt vmcnt(10)
  v_mfma_f32_32x32x16_bf16 v[192:207], v[184:187], v[136:139], v[192:207]
  v_mfma_f32_32x32x16_bf16 v[224:239], v[188:191], v[136:139], v[224:239]
  v_mfma_f32_32x32x16_bf16 v[240:255], v[188:191], v[140:143], v[240:255]
  v_mfma_f32_32x32x16_bf16 v[208:223], v[184:187], v[140:143], v[208:223]
  buffer_load_dwordx4 v[136:139], v3, s[16:19], s33 offen offset:2048
  buffer_load_dwordx4 v[140:143], v3, s[16:19], s33 offen offset:3072
  s_add_u32 s33, s33, 4096
  s_waitcnt vmcnt(10)
  v_mfma_f32_32x32x16_bf16 v[192:207], v[32:35], v[96:99], v[192:207]
  v_mfma_f32_32x32x16_bf16 v[224:239], v[36:39], v[96:99], v[224:239]
  v_mfma_f32_32x32x16_bf16 v[240:255], v[36:39], v[100:103], v[240:255]
  v_mfma_f32_32x32x16_bf16 v[208:223], v[32:35], v[100:103], v[208:223]
  buffer_load_dwordx4 v[96:99], v3, s[16:19], s33 offen offset:0
  buffer_load_dwordx4 v[100:103], v3, s[16:19], s33 offen offset:1024
  s_waitcnt vmcnt(10)
  v_mfma_f32_32x32x16_bf16 v[192:207], v[40:43], v[104:107], v[192:207]
  v_mfma_f32_32x32x16_bf16 v[224:239], v[44:47], v[104:107], v[224:239]
  v_mfma_f32_32x32x16_bf16 v[240:255], v[44:47], v[108:111], v[240:255]
  v_mfma_f32_32x32x16_bf16 v[208:223], v[40:43], v[108:111], v[208:223]
  buffer_load_dwordx4 v[104:107], v3, s[16:19], s33 offen offset:2048
  buffer_load_dwordx4 v[108:111], v3, s[16:19], s33 offen offset:3072
  s_add_u32 s33, s33, 4096
  s_waitcnt vmcnt(10)
  v_mfma_f32_32x32x16_bf16 v[192:207], v[48:51], v[112:115], v[192:207]
  v_mfma_f32_32x32x16_bf16 v[224:239], v[52:55], v[112:115], v[224:239]
  v_mfma_f32_32x32x16_bf16 v[240:255], v[52:55], v[116:119], v[240:255]
  v_mfma_f32_32x32x16_bf16 v[208:223], v[48:51], v[116:119], v[208:223]
  s_waitcnt vmcnt(8)
  v_mfma_f32_32x32x16_bf16 v[192:207], v[56:59], v[120:123], v[192:207]
  v_mfma_f32_32x32x16_bf16 v[224:239], v[60:63], v[120:123], v[224:239]
  v_mfma_f32_32x32x16_bf16 v[240:255], v[60:63], v[124:127], v[240:255]
  v_mfma_f32_32x32x16_bf16 v[208:223], v[56:59], v[124:127], v[208:223]
  s_waitcnt vmcnt(6)
  v_mfma_f32_32x32x16_bf16 v[192:207], v[64:67], v[128:131], v[192:207]
  v_mfma_f32_32x32x16_bf16 v[224:239], v[68:71], v[128:131], v[224:239]
  v_mfma_f32_32x32x16_bf16 v[240:255], v[68:71], v[132:135], v[240:255]
  v_mfma_f32_32x32x16_bf16 v[208:223], v[64:67], v[132:135], v[208:223]
  buffer_load_dwordx4 v[4:7], v3, s[16:19], s60 offen sc1
  s_waitcnt vmcnt(5)
  v_mfma_f32_32x32x16_bf16 v[192:207], v[72:75], v[136:139], v[192:207]
  v_mfma_f32_32x32x16_bf16 v[224:239], v[76:79], v[136:139], v[224:239]
  v_mfma_f32_32x32x16_bf16 v[240:255], v[76:79], v[140:143], v[240:255]
  v_mfma_f32_32x32x16_bf16 v[208:223], v[72:75], v[140:143], v[208:223]
  s_waitcnt vmcnt(3)
  v_mfma_f32_32x32x16_bf16 v[192:207], v[80:83], v[96:99], v[192:207]
  v_mfma_f32_32x32x16_bf16 v[224:239], v[84:87], v[96:99], v[224:239]
  v_mfma_f32_32x32x16_bf16 v[240:255], v[84:87], v[100:103], v[240:255]
  v_mfma_f32_32x32x16_bf16 v[208:223], v[80:83], v[100:103], v[208:223]
  s_waitcnt vmcnt(1)
  v_mfma_f32_32x32x16_bf16 v[192:207], v[88:91], v[104:107], v[192:207]
  v_mfma_f32_32x32x16_bf16 v[224:239], v[92:95], v[104:107], v[224:239]
  v_mfma_f32_32x32x16_bf16 v[240:255], v[92:95], v[108:111], v[240:255]
  v_mfma_f32_32x32x16_bf16 v[208:223], v[88:91], v[108:111], v[208:223]
  v_and_b32 v26, 15, v24
  v_lshlrev_b32 v27, 1, v25
  v_xor_b32 v26, v26, v27
  v_lshlrev_b32 v27, 8, v24
  v_lshl_add_u32 v96, v26, 4, v27
  v_xor_b32 v97, 16, v96
  v_add_u32 v98, 65536, v96
  v_add_u32 v99, 65536, v97
  v_lshlrev_b32 v26, 10, v25
  v_bfe_u32 v27, v23, 2, 2
  v_lshl_add_u32 v26, v27, 7, v26
  v_and_b32 v27, 3, v23
  v_lshl_add_u32 v26, v27, 3, v26
  s_lshr_b32 s30, s20, 1
  s_lshl_b32 s30, s30, 5
  s_add_u32 s30, s30, 152576
  v_add_u32 v100, s30, v26
  ds_write_b128 v16, v[192:195] offset:0
  v_xor_b32 v17, 32, v16
  ds_write_b128 v17, v[196:199] offset:0
  v_xor_b32 v17, 64, v16
  ds_write_b128 v17, v[200:203] offset:0
  v_xor_b32 v17, 96, v16
  ds_write_b128 v17, v[204:207] offset:0
  v_xor_b32 v17, 128, v16
  ds_write_b128 v17, v[224:227] offset:0
  v_xor_b32 v17, 160, v16
  ds_write_b128 v17, v[228:231] offset:0
  v_xor_b32 v17, 192, v16
  ds_write_b128 v17, v[232:235] offset:0
  v_xor_b32 v17, 224, v16
  ds_write_b128 v17, v[236:239] offset:0
  v_xor_b32 v17, 128, v16
  ds_write_b128 v17, v[240:243] offset:8192
  v_xor_b32 v17, 160, v16
  ds_write_b128 v17, v[244:247] offset:8192
  v_xor_b32 v17, 192, v16
  ds_write_b128 v17, v[248:251] offset:8192
  v_xor_b32 v17, 224, v16
  ds_write_b128 v17, v[252:255] offset:8192
  ds_write_b128 v16, v[208:211] offset:8192
  v_xor_b32 v17, 32, v16
  ds_write_b128 v17, v[212:215] offset:8192
  v_xor_b32 v17, 64, v16
  ds_write_b128 v17, v[216:219] offset:8192
  v_xor_b32 v17, 96, v16
  ds_write_b128 v17, v[220:223] offset:8192
  v_rcp_f32 v11, v11
  v_lshlrev_b32 v104, 16, v12
  v_and_b32 v105, 0xffff0000, v12
  v_lshlrev_b32 v106, 16, v13
  v_and_b32 v107, 0xffff0000, v13
  v_lshlrev_b32 v108, 16, v14
  v_and_b32 v109, 0xffff0000, v14
  v_lshlrev_b32 v110, 16, v15
  v_and_b32 v111, 0xffff0000, v15
  v_sub_f32 v112, v104, v10
  v_mul_f32 v112, v112, v11
  v_sub_f32 v113, v105, v10
  v_mul_f32 v113, v113, v11
  v_sub_f32 v114, v106, v10
  v_mul_f32 v114, v114, v11
  v_sub_f32 v115, v107, v10
  v_mul_f32 v115, v115, v11
  v_sub_f32 v116, v108, v10
  v_mul_f32 v116, v116, v11
  v_sub_f32 v117, v109, v10
  v_mul_f32 v117, v117, v11
  v_sub_f32 v118, v110, v10
  v_mul_f32 v118, v118, v11
  v_sub_f32 v119, v111, v10
  v_mul_f32 v119, v119, v11
  s_mov_b32 s62, 0x4000
  s_branch K_yp_c
K_yp:
  s_sleep 4
  buffer_load_dwordx4 v[4:7], v3, s[16:19], s60 offen sc1
  s_sub_u32 s62, s62, 1
K_yp_c:
  s_waitcnt vmcnt(0)
  v_max_u32 v29, v4, v5
  v_max3_u32 v29, v29, v6, v7
  v_cmp_eq_u32 vcc, -1, v29
  s_cmp_eq_u32 s62, 0
  s_cbranch_scc1 K_yp_x
  s_nop 1
  s_cbranch_vccnz K_yp
K_yp_x:
  ds_write_b128 v18, v[4:7] offset:8192
  s_waitcnt lgkmcnt(0)
  s_barrier
  ds_read_b64_tr_b16 v[120:121], v100
  ds_read_b64_tr_b16 v[122:123], v100 offset:512
  ds_read_b128 v[192:195], v96 offset:0
  ds_read_b128 v[196:199], v97 offset:0
  ds_read_b128 v[200:203], v96 offset:16384
  ds_read_b128 v[204:207], v97 offset:16384
  ds_read_b128 v[208:211], v96 offset:32768
  ds_read_b128 v[212:215], v97 offset:32768
  ds_read_b128 v[216:219], v96 offset:49152
  ds_read_b128 v[220:223], v97 offset:49152
  ds_read_b128 v[224:227], v98 offset:0
  ds_read_b128 v[228:231], v99 offset:0
  ds_read_b128 v[232:235], v98 offset:16384
  ds_read_b128 v[236:239], v99 offset:16384
  s_waitcnt lgkmcnt(12)
  ds_read_b128 v[240:243], v98 offset:32768
  ds_read_b128 v[244:247], v99 offset:32768
  v_lshlrev_b32 v26, 16, v120
  v_and_b32 v27, 0xffff0000, v120
  v_fma_f32 v104, v112, v26, v104
  v_fma_f32 v105, v113, v27, v105
  v_lshlrev_b32 v26, 16, v121
  v_and_b32 v27, 0xffff0000, v121
  v_fma_f32 v106, v114, v26, v106
  v_fma_f32 v107, v115, v27, v107
  v_lshlrev_b32 v26, 16, v122
  v_and_b32 v27, 0xffff0000, v122
  v_fma_f32 v108, v116, v26, v108
  v_fma_f32 v109, v117, v27, v109
  v_lshlrev_b32 v26, 16, v123
  v_and_b32 v27, 0xffff0000, v123
  v_fma_f32 v110, v118, v26, v110
  v_fma_f32 v111, v119, v27, v111
  s_waitcnt lgkmcnt(12)
  ds_read_b128 v[248:251], v98 offset:49152
  ds_read_b128 v[252:255], v99 offset:49152
  v_pk_add_f32 v[104:105], v[104:105], v[192:193]
  v_pk_add_f32 v[106:107], v[106:107], v[194:195]
  v_pk_add_f32 v[108:109], v[108:109], v[196:197]
  v_pk_add_f32 v[110:111], v[110:111], v[198:199]
  s_waitcnt lgkmcnt(12)
  v_pk_add_f32 v[104:105], v[104:105], v[200:201]
  v_pk_add_f32 v[106:107], v[106:107], v[202:203]
  v_pk_add_f32 v[108:109], v[108:109], v[204:205]
  v_pk_add_f32 v[110:111], v[110:111], v[206:207]
  s_waitcnt lgkmcnt(10)
  v_pk_add_f32 v[104:105], v[104:105], v[208:209]
  v_pk_add_f32 v[106:107], v[106:107], v[210:211]
  v_pk_add_f32 v[108:109], v[108:109], v[212:213]
  v_pk_add_f32 v[110:111], v[110:111], v[214:215]
  s_waitcnt lgkmcnt(8)
  v_pk_add_f32 v[104:105], v[104:105], v[216:217]
  v_pk_add_f32 v[106:107], v[106:107], v[218:219]
  v_pk_add_f32 v[108:109], v[108:109], v[220:221]
  v_pk_add_f32 v[110:111], v[110:111], v[222:223]
  s_waitcnt lgkmcnt(6)
  v_pk_add_f32 v[104:105], v[104:105], v[224:225]
  v_pk_add_f32 v[106:107], v[106:107], v[226:227]
  v_pk_add_f32 v[108:109], v[108:109], v[228:229]
  v_pk_add_f32 v[110:111], v[110:111], v[230:231]
  s_waitcnt lgkmcnt(4)
  v_pk_add_f32 v[104:105], v[104:105], v[232:233]
  v_pk_add_f32 v[106:107], v[106:107], v[234:235]
  v_pk_add_f32 v[108:109], v[108:109], v[236:237]
  v_pk_add_f32 v[110:111], v[110:111], v[238:239]
  s_waitcnt lgkmcnt(2)
  v_pk_add_f32 v[104:105], v[104:105], v[240:241]
  v_pk_add_f32 v[106:107], v[106:107], v[242:243]
  v_pk_add_f32 v[108:109], v[108:109], v[244:245]
  v_pk_add_f32 v[110:111], v[110:111], v[246:247]
  s_waitcnt lgkmcnt(0)
  v_pk_add_f32 v[104:105], v[104:105], v[248:249]
  v_pk_add_f32 v[106:107], v[106:107], v[250:251]
  v_pk_add_f32 v[108:109], v[108:109], v[252:253]
  v_pk_add_f32 v[110:111], v[110:111], v[254:255]
  v_cvt_pk_bf16_f32 v120, v104, v105
  v_cvt_pk_bf16_f32 v121, v106, v107
  v_cvt_pk_bf16_f32 v122, v108, v109
  v_cvt_pk_bf16_f32 v123, v110, v111
  buffer_store_dwordx4 v[120:123], v8, s[12:15], s21 offen
K_end:
  s_endpgm
K_pre:
  s_waitcnt lgkmcnt(0)
  s_load_dwordx2 s[8:9], s[0:1], 72
  s_cmp_lg_u32 s2, 255
  s_cbranch_scc1 K_nn
  s_cmp_lg_u32 s20, 0
  s_cbranch_scc1 K_nn
  s_memrealtime s[68:69]
  v_mov_b32 v2, 0
  s_waitcnt lgkmcnt(0)
  s_or_b32 s68, s68, 1
  v_mov_b32 v4, s68
  v_mov_b32 v5, s69
  global_store_dwordx2 v2, v[4:5], s[14:15] sc1
K_nn:
  s_sub_u32 s28, s2, 224
  s_lshl_b32 s29, s28, 16
  v_lshrrev_b32 v10, 3, v23
  v_and_b32 v11, 7, v23
  v_lshlrev_b32 v12, 10, v10
  v_lshl_add_u32 v12, v11, 4, v12
  s_lshl_b32 s49, s20, 13
  s_add_u32 s30, s29, s49
  s_mov_b32 s6, 2097152
  s_mov_b32 s7, 0x20000
  s_mov_b32 s18, 16777216
  s_mov_b32 s19, 0x20000
  buffer_load_dwordx4 v[32:35], v12, s[4:7], s30 offen offset:0
  buffer_load_dwordx4 v[36:39], v12, s[4:7], s30 offen offset:128
  buffer_load_dwordx4 v[40:43], v12, s[4:7], s30 offen offset:256
  buffer_load_dwordx4 v[44:47], v12, s[4:7], s30 offen offset:384
  buffer_load_dwordx4 v[48:51], v12, s[4:7], s30 offen offset:512
  buffer_load_dwordx4 v[52:55], v12, s[4:7], s30 offen offset:640
  buffer_load_dwordx4 v[56:59], v12, s[4:7], s30 offen offset:768
  buffer_load_dwordx4 v[60:63], v12, s[4:7], s30 offen offset:896
  v_and_b32 v8, 1, v24
  v_lshrrev_b32 v9, 5, v23
  v_lshlrev_b32 v6, 3, v25
  v_lshl_add_u32 v6, v8, 12, v6
  v_lshl_add_u32 v6, v9, 14, v6
  v_and_b32 v7, 7, v25
  v_lshlrev_b32 v7, 6, v7
  v_lshl_add_u32 v7, v8, 9, v7
  v_lshl_add_u32 v7, v9, 11, v7
  v_lshrrev_b32 v8, 3, v25
  v_lshl_add_u32 v7, v8, 10, v7
  s_and_b32 s30, s28, 3
  s_mul_i32 s21, s30, 28
  s_lshr_b32 s22, s28, 2
  s_lshl_b32 s22, s22, 7
  s_mov_b32 s54, 0x05040100
  s_mov_b32 s55, 0x07060302
  s_waitcnt lgkmcnt(0)
  s_mov_b32 s10, 1835008
  s_mov_b32 s11, 0x20000
  s_lshl_b32 s30, s20, 1
  s_mul_i32 s60, s28, 28
  s_add_u32 s60, s60, s30
  s_lshl_b32 s60, s60, 11
  s_add_u32 s60, s60, 8388608
  s_add_u32 s30, s30, s21
  s_lshl_b32 s30, s30, 14
  s_add_u32 s30, s30, s22
  s_add_u32 s31, s30, 8192
  buffer_load_dwordx2 v[64:65], v6, s[8:11], s30 offen offset:0
  buffer_load_dwordx2 v[66:67], v6, s[8:11], s30 offen offset:1024
  buffer_load_dwordx2 v[68:69], v6, s[8:11], s30 offen offset:2048
  buffer_load_dwordx2 v[70:71], v6, s[8:11], s30 offen offset:3072
  buffer_load_dwordx2 v[72:73], v6, s[8:11], s31 offen offset:0
  buffer_load_dwordx2 v[74:75], v6, s[8:11], s31 offen offset:1024
  buffer_load_dwordx2 v[76:77], v6, s[8:11], s31 offen offset:2048
  buffer_load_dwordx2 v[78:79], v6, s[8:11], s31 offen offset:3072
  s_min_u32 s30, s20, 5
  s_lshl_b32 s30, s30, 1
  s_add_u32 s30, s30, 16
  s_mul_i32 s61, s28, 28
  s_add_u32 s61, s61, s30
  s_lshl_b32 s61, s61, 11
  s_add_u32 s61, s61, 8388608
  s_add_u32 s30, s30, s21
  s_lshl_b32 s30, s30, 14
  s_add_u32 s30, s30, s22
  s_add_u32 s31, s30, 8192
  buffer_load_dwordx2 v[80:81], v6, s[8:11], s30 offen offset:0
  buffer_load_dwordx2 v[82:83], v6, s[8:11], s30 offen offset:1024
  buffer_load_dwordx2 v[84:85], v6, s[8:11], s30 offen offset:2048
  buffer_load_dwordx2 v[86:87], v6, s[8:11], s30 offen offset:3072
  buffer_load_dwordx2 v[88:89], v6, s[8:11], s31 offen offset:0
  buffer_load_dwordx2 v[90:91], v6, s[8:11], s31 offen offset:1024
  buffer_load_dwordx2 v[92:93], v6, s[8:11], s31 offen offset:2048
  buffer_load_dwordx2 v[94:95], v6, s[8:11], s31 offen offset:3072
  s_and_b32 s50, s26, 3
  s_lshl_b32 s50, s50, 3
  s_and_b32 s30, s27, 7
  s_add_u32 s50, s50, s30
  s_lshr_b32 s51, s26, 2
  s_lshl_b32 s51, s51, 2
  s_lshr_b32 s30, s27, 3
  s_add_u32 s51, s51, s30
  s_mov_b64 s[44:45], s[14:15]
  s_mov_b32 s46, 256
  s_mov_b32 s47, 0x20000
  s_mov_b32 s14, 2097152
  s_mov_b32 s15, 0x20000
  s_lshr_b32 s48, s20, 2
  s_lshl_b32 s36, s2, 1
  s_add_u32 s36, s36, s48
  s_lshl_b32 s30, s36, 12
  s_add_u32 s40, s56, s30
  s_addc_u32 s41, s57, 0
  s_mov_b32 s42, 4096
  s_mov_b32 s43, 0x20000
  s_lshl_b32 s30, s2, 2
  s_load_dword s37, s[58:59], s30
  v_and_b32 v28, 255, v0
  v_lshlrev_b32 v28, 4, v28
  v_subrev_u32 v26, 16, v28
  v_max_i32 v27, 0, v26
  s_lshl_b32 s39, s20, 24
  s_add_u32 s39, s39, 14745600
  s_lshl_b32 s23, s2, 7
  s_add_u32 s23, s23, s39
  s_lshr_b32 s30, s2, 5
  v_lshl_add_u32 v242, v23, 3, s30
  s_lshl_b32 s30, s51, 2
  s_add_u32 s30, s30, 192
  v_add_u32 v243, s30, v23
  v_cmp_gt_u32 vcc, 32, v23
  v_cndmask_b32 v242, v243, v242, vcc
  s_add_u32 s30, s50, 256
  v_mov_b32 v243, s30
  v_cmp_gt_u32 vcc, 36, v23
  v_cndmask_b32 v242, v243, v242, vcc
  v_lshl_add_u32 v242, v242, 7, s39
  s_mov_b64 s[92:93], s[66:67]
  s_mov_b32 s66, 2097152
  s_mov_b32 s67, 0x20000
  s_mov_b32 s94, 2097152
  s_mov_b32 s95, 0x20000
  s_mov_b32 s98, 4096
  s_mov_b32 s99, 0x20000
  s_cmp_ge_u32 s20, 4
  s_cbranch_scc1 K_kl2
  v_and_b32 v236, 7, v23
  v_lshrrev_b32 v237, 3, v23
  s_lshl_b32 s30, s27, 16
  s_lshl_b32 s31, s26, 7
  s_add_u32 s30, s30, s31
  s_lshl_b32 s31, s20, 5
  s_add_u32 s30, s30, s31
  v_lshlrev_b32 v238, 13, v236
  v_lshl_add_u32 v238, v237, 2, v238
  v_add_u32 v238, s30, v238
  v_subrev_u32 v239, 3072, v238
  s_lshl_b32 s30, s26, 9
  s_lshl_b32 s31, s20, 7
  s_add_u32 s30, s30, s31
  v_lshrrev_b32 v240, 3, v23
  v_lshlrev_b32 v240, 4, v240
  s_movk_i32 s31, 4096
  buffer_load_dwordx4 v[224:227], v240, s[96:99], s30 offen
  buffer_load_dword v204, v239, s[64:67], 0 offen offset:0
  buffer_load_dword v205, v239, s[64:67], 0 offen offset:1024
  buffer_load_dword v206, v239, s[64:67], 0 offen offset:2048
  buffer_load_dword v207, v238, s[64:67], 0 offen offset:0
  buffer_load_dword v208, v238, s[64:67], 0 offen offset:1024
  buffer_load_dword v209, v238, s[64:67], 0 offen offset:2048
  buffer_load_dword v210, v238, s[64:67], 0 offen offset:3072
  buffer_load_dword v211, v238, s[64:67], s31 offen offset:0
  buffer_load_dword v212, v238, s[64:67], s31 offen offset:1024
  buffer_load_dword v213, v238, s[64:67], s31 offen offset:2048
  buffer_load_dword v214, v238, s[64:67], s31 offen offset:3072
  buffer_load_dword v215, v238, s[92:95], 0 offen offset:0
  buffer_load_dword v216, v238, s[92:95], 0 offen offset:1024
  buffer_load_dword v217, v238, s[92:95], 0 offen offset:2048
  buffer_load_dword v218, v238, s[92:95], 0 offen offset:3072
  buffer_load_dword v219, v238, s[92:95], s31 offen offset:0
  buffer_load_dword v220, v238, s[92:95], s31 offen offset:1024
  buffer_load_dword v221, v238, s[92:95], s31 offen offset:2048
  buffer_load_dword v222, v238, s[92:95], s31 offen offset:3072
K_kl2:
  s_mov_b32 s52, 0
  s_mov_b32 s38, 0x3f803f80
  v_mov_b32 v16, 0
  v_mov_b32 v17, 0
  s_cmp_lt_u32 s20, 4
  s_cbranch_scc1 K_w2_a
  s_waitcnt vmcnt(16)
K_w2_a:
  s_waitcnt vmcnt(36) lgkmcnt(0)
  s_load_dwordx2 s[68:69], s[44:45], 0
  v_dot2c_f32_bf16 v16, s38, v32
  v_dot2c_f32_bf16 v17, v32, v32
  v_dot2c_f32_bf16 v16, s38, v33
  v_dot2c_f32_bf16 v17, v33, v33
  v_dot2c_f32_bf16 v16, s38, v34
  v_dot2c_f32_bf16 v17, v34, v34
  v_dot2c_f32_bf16 v16, s38, v35
  v_dot2c_f32_bf16 v17, v35, v35
  v_dot2c_f32_bf16 v16, s38, v36
  v_dot2c_f32_bf16 v17, v36, v36
  v_dot2c_f32_bf16 v16, s38, v37
  v_dot2c_f32_bf16 v17, v37, v37
  v_dot2c_f32_bf16 v16, s38, v38
  v_dot2c_f32_bf16 v17, v38, v38
  v_dot2c_f32_bf16 v16, s38, v39
  v_dot2c_f32_bf16 v17, v39, v39
  v_dot2c_f32_bf16 v16, s38, v40
  v_dot2c_f32_bf16 v17, v40, v40
  v_dot2c_f32_bf16 v16, s38, v41
  v_dot2c_f32_bf16 v17, v41, v41
  v_dot2c_f32_bf16 v16, s38, v42
  v_dot2c_f32_bf16 v17, v42, v42
  v_dot2c_f32_bf16 v16, s38, v43
  v_dot2c_f32_bf16 v17, v43, v43
  v_dot2c_f32_bf16 v16, s38, v44
  v_dot2c_f32_bf16 v17, v44, v44
  v_dot2c_f32_bf16 v16, s38, v45
  v_dot2c_f32_bf16 v17, v45, v45
  v_dot2c_f32_bf16 v16, s38, v46
  v_dot2c_f32_bf16 v17, v46, v46
  v_dot2c_f32_bf16 v16, s38, v47
  v_dot2c_f32_bf16 v17, v47, v47
  v_dot2c_f32_bf16 v16, s38, v48
  v_dot2c_f32_bf16 v17, v48, v48
  v_dot2c_f32_bf16 v16, s38, v49
  v_dot2c_f32_bf16 v17, v49, v49
  v_dot2c_f32_bf16 v16, s38, v50
  v_dot2c_f32_bf16 v17, v50, v50
  v_dot2c_f32_bf16 v16, s38, v51
  v_dot2c_f32_bf16 v17, v51, v51
  v_dot2c_f32_bf16 v16, s38, v52
  v_dot2c_f32_bf16 v17, v52, v52
  v_dot2c_f32_bf16 v16, s38, v53
  v_dot2c_f32_bf16 v17, v53, v53
  v_dot2c_f32_bf16 v16, s38, v54
  v_dot2c_f32_bf16 v17, v54, v54
  v_dot2c_f32_bf16 v16, s38, v55
  v_dot2c_f32_bf16 v17, v55, v55
  v_dot2c_f32_bf16 v16, s38, v56
  v_dot2c_f32_bf16 v17, v56, v56
  v_dot2c_f32_bf16 v16, s38, v57
  v_dot2c_f32_bf16 v17, v57, v57
  v_dot2c_f32_bf16 v16, s38, v58
  v_dot2c_f32_bf16 v17, v58, v58
  v_dot2c_f32_bf16 v16, s38, v59
  v_dot2c_f32_bf16 v17, v59, v59
  v_dot2c_f32_bf16 v16, s38, v60
  v_dot2c_f32_bf16 v17, v60, v60
  v_dot2c_f32_bf16 v16, s38, v61
  v_dot2c_f32_bf16 v17, v61, v61
  v_dot2c_f32_bf16 v16, s38, v62
  v_dot2c_f32_bf16 v17, v62, v62
  v_dot2c_f32_bf16 v16, s38, v63
  v_dot2c_f32_bf16 v17, v63, v63
  s_nop 2
  v_add_f32_dpp v16, v16, v16 quad_perm:[1,0,3,2] row_mask:0xf bank_mask:0xf
  v_add_f32_dpp v17, v17, v17 quad_perm:[1,0,3,2] row_mask:0xf bank_mask:0xf
  s_nop 1
  v_add_f32_dpp v16, v16, v16 quad_perm:[2,3,0,1] row_mask:0xf bank_mask:0xf
  v_add_f32_dpp v17, v17, v17 quad_perm:[2,3,0,1] row_mask:0xf bank_mask:0xf
  s_nop 1
  v_add_f32_dpp v16, v16, v16 row_half_mirror row_mask:0xf bank_mask:0xf
  v_add_f32_dpp v17, v17, v17 row_half_mirror row_mask:0xf bank_mask:0xf
  s_nop 1
  v_mul_f32 v16, 0x3b000000, v16
  v_mul_f32 v17, 0x3b000000, v17
  v_fma_f32 v17, -v16, v16, v17
  v_cvt_pk_bf16_f32 v16, v16, v16
  v_max_f32 v17, 0, v17
  v_and_b32 v16, 0xffff0000, v16
  v_cvt_pk_bf16_f32 v17, v17, v17
  v_and_b32 v17, 0xffff0000, v17
  v_add_f32 v17, 0x3727c5ac, v17
  v_cvt_pk_bf16_f32 v17, v17, v17
  v_and_b32 v17, 0xffff0000, v17
  v_sqrt_f32 v17, v17
  s_nop 0
  v_cvt_pk_bf16_f32 v17, v17, v17
  v_and_b32 v17, 0xffff0000, v17
  v_lshlrev_b32 v10, 3, v10
  s_lshl_b32 s30, s28, 9
  s_lshl_b32 s31, s20, 6
  s_add_u32 s30, s30, s31
  s_add_u32 s30, s30, 14680064
  v_cmp_eq_u32 vcc, 0, v11
  s_mov_b64 exec, vcc
  buffer_store_dwordx2 v[16:17], v10, s[16:19], s30 offen sc1
  s_mov_b64 exec, -1
  v_lshlrev_b32 v3, 4, v23
  v_add_u32 v7, s49, v7
  v_add_u32 v13, s49, v3
  s_waitcnt vmcnt(1)
  v_perm_b32 v32, v66, v64, s54
  v_perm_b32 v33, v70, v68, s54
  v_perm_b32 v34, v74, v72, s54
  v_perm_b32 v35, v78, v76, s54
  ds_write_b128 v7, v[32:35] offset:0
  v_perm_b32 v36, v66, v64, s55
  v_perm_b32 v37, v70, v68, s55
  v_perm_b32 v38, v74, v72, s55
  v_perm_b32 v39, v78, v76, s55
  ds_write_b128 v7, v[36:39] offset:16
  v_perm_b32 v40, v67, v65, s54
  v_perm_b32 v41, v71, v69, s54
  v_perm_b32 v42, v75, v73, s54
  v_perm_b32 v43, v79, v77, s54
  ds_write_b128 v7, v[40:43] offset:32
  v_perm_b32 v44, v67, v65, s55
  v_perm_b32 v45, v71, v69, s55
  v_perm_b32 v46, v75, v73, s55
  v_perm_b32 v47, v79, v77, s55
  ds_write_b128 v7, v[44:47] offset:48
  v_perm_b32 v48, v82, v80, s54
  v_perm_b32 v49, v86, v84, s54
  v_perm_b32 v50, v90, v88, s54
  v_perm_b32 v51, v94, v92, s54
  ds_write_b128 v7, v[48:51] offset:4096
  v_perm_b32 v52, v82, v80, s55
  v_perm_b32 v53, v86, v84, s55
  v_perm_b32 v54, v90, v88, s55
  v_perm_b32 v55, v94, v92, s55
  ds_write_b128 v7, v[52:55] offset:4112
  v_perm_b32 v56, v83, v81, s54
  v_perm_b32 v57, v87, v85, s54
  v_perm_b32 v58, v91, v89, s54
  v_perm_b32 v59, v95, v93, s54
  ds_write_b128 v7, v[56:59] offset:4128
  v_perm_b32 v60, v83, v81, s55
  v_perm_b32 v61, v87, v85, s55
  v_perm_b32 v62, v91, v89, s55
  v_perm_b32 v63, v95, v93, s55
  ds_write_b128 v7, v[60:63] offset:4144
  ds_read_b128 v[64:67], v13 offset:0
  ds_read_b128 v[68:71], v13 offset:1024
  ds_read_b128 v[72:75], v13 offset:2048
  ds_read_b128 v[76:79], v13 offset:3072
  ds_read_b128 v[80:83], v13 offset:4096
  ds_read_b128 v[84:87], v13 offset:5120
  ds_read_b128 v[88:91], v13 offset:6144
  ds_read_b128 v[92:95], v13 offset:7168
  s_waitcnt vmcnt(0) lgkmcnt(0)
  s_barrier
  s_add_u32 s30, s23, 4096
  s_cmp_lg_u64 s[68:69], 0
  s_cbranch_scc1 K_pn2_x
  s_mov_b32 s62, 0x4000
K_pn2:
  s_sleep 3
  buffer_load_dwordx2 v[30:31], off, s[44:47], 0 sc1
  s_sub_u32 s62, s62, 1
  s_waitcnt vmcnt(0)
K_pn2_c:
  v_cmp_eq_u64 vcc, 0, v[30:31]
  s_cmp_eq_u32 s62, 0
  s_cbranch_scc1 K_pn2_y
  s_cmp_lg_u64 vcc, 0
  s_cbranch_scc1 K_pn2
K_pn2_y:
  v_readfirstlane_b32 s68, v30
  v_readfirstlane_b32 s69, v31
  s_nop 1
K_pn2_x:
  v_mov_b32 v21, s30
  v_mov_b32 v18, s68
  v_mov_b32 v19, s69
  s_mov_b64 exec, 1
  buffer_store_dwordx2 v[18:19], v21, s[16:19], 0 offen sc1
  s_mov_b64 exec, -1
  s_waitcnt lgkmcnt(7)
  buffer_store_dwordx4 v[64:67], v3, s[16:19], s60 offen offset:0 sc1
  s_waitcnt lgkmcnt(6)
  buffer_store_dwordx4 v[68:71], v3, s[16:19], s60 offen offset:1024 sc1
  s_waitcnt lgkmcnt(5)
  buffer_store_dwordx4 v[72:75], v3, s[16:19], s60 offen offset:2048 sc1
  s_waitcnt lgkmcnt(4)
  buffer_store_dwordx4 v[76:79], v3, s[16:19], s60 offen offset:3072 sc1
  s_waitcnt lgkmcnt(3)
  buffer_store_dwordx4 v[80:83], v3, s[16:19], s61 offen offset:0 sc1
  s_waitcnt lgkmcnt(2)
  buffer_store_dwordx4 v[84:87], v3, s[16:19], s61 offen offset:1024 sc1
  s_waitcnt lgkmcnt(1)
  buffer_store_dwordx4 v[88:91], v3, s[16:19], s61 offen offset:2048 sc1
  s_waitcnt lgkmcnt(0)
  buffer_store_dwordx4 v[92:95], v3, s[16:19], s61 offen offset:3072 sc1
  s_cmp_lt_u32 s20, 4
  s_cbranch_scc1 K_kc2_k
  v_lshlrev_b32 v240, 4, v23
  s_lshl_b32 s30, s2, 13
  s_lshl_b32 s31, s20, 11
  s_add_u32 s30, s30, s31
  s_add_u32 s30, s30, 12574720
  v_mov_b32 v228, -1
  v_mov_b32 v229, -1
  v_mov_b32 v230, -1
  v_mov_b32 v231, -1
  buffer_store_dwordx4 v[228:231], v240, s[16:19], s30 offen sc1
  buffer_store_dwordx4 v[228:231], v240, s[16:19], s30 offen offset:1024 sc1
  s_branch K_kc2_e
K_kc2_k:
  v_lshlrev_b32 v134, 16, v224
  v_lshlrev_b32 v135, 16, v226
  v_and_b32 v136, 0xffff0000, v224
  v_and_b32 v137, 0xffff0000, v226
  v_lshlrev_b32 v138, 16, v225
  v_lshlrev_b32 v139, 16, v227
  v_and_b32 v140, 0xffff0000, v225
  v_and_b32 v141, 0xffff0000, v227
  v_lshlrev_b32 v96, 16, v204
  v_and_b32 v97, 0xffff0000, v204
  v_lshlrev_b32 v98, 16, v205
  v_and_b32 v99, 0xffff0000, v205
  v_lshlrev_b32 v100, 16, v206
  v_and_b32 v101, 0xffff0000, v206
  v_lshlrev_b32 v102, 16, v207
  v_and_b32 v103, 0xffff0000, v207
  v_lshlrev_b32 v104, 16, v208
  v_and_b32 v105, 0xffff0000, v208
  v_lshlrev_b32 v106, 16, v209
  v_and_b32 v107, 0xffff0000, v209
  v_lshlrev_b32 v108, 16, v210
  v_and_b32 v109, 0xffff0000, v210
  v_lshlrev_b32 v110, 16, v211
  v_and_b32 v111, 0xffff0000, v211
  v_lshlrev_b32 v112, 16, v212
  v_and_b32 v113, 0xffff0000, v212
  v_lshlrev_b32 v114, 16, v213
  v_and_b32 v115, 0xffff0000, v213
  v_lshlrev_b32 v116, 16, v214
  v_and_b32 v117, 0xffff0000, v214
  v_pk_mul_f32 v[118:119], v[96:97], v[140:141]
  v_pk_mul_f32 v[120:121], v[98:99], v[140:141]
  v_pk_mul_f32 v[122:123], v[100:101], v[140:141]
  v_pk_mul_f32 v[124:125], v[102:103], v[140:141]
  v_pk_mul_f32 v[126:127], v[104:105], v[140:141]
  v_pk_mul_f32 v[128:129], v[106:107], v[140:141]
  v_pk_mul_f32 v[130:131], v[108:109], v[140:141]
  v_pk_mul_f32 v[132:133], v[110:111], v[140:141]
  v_pk_fma_f32 v[118:119], v[98:99], v[138:139], v[118:119]
  v_pk_fma_f32 v[120:121], v[100:101], v[138:139], v[120:121]
  v_pk_fma_f32 v[122:123], v[102:103], v[138:139], v[122:123]
  v_pk_fma_f32 v[124:125], v[104:105], v[138:139], v[124:125]
  v_pk_fma_f32 v[126:127], v[106:107], v[138:139], v[126:127]
  v_pk_fma_f32 v[128:129], v[108:109], v[138:139], v[128:129]
  v_pk_fma_f32 v[130:131], v[110:111], v[138:139], v[130:131]
  v_pk_fma_f32 v[132:133], v[112:113], v[138:139], v[132:133]
  v_pk_fma_f32 v[118:119], v[100:101], v[136:137], v[118:119]
  v_pk_fma_f32 v[120:121], v[102:103], v[136:137], v[120:121]
  v_pk_fma_f32 v[122:123], v[104:105], v[136:137], v[122:123]
  v_pk_fma_f32 v[124:125], v[106:107], v[136:137], v[124:125]
  v_pk_fma_f32 v[126:127], v[108:109], v[136:137], v[126:127]
  v_pk_fma_f32 v[128:129], v[110:111], v[136:137], v[128:129]
  v_pk_fma_f32 v[130:131], v[112:113], v[136:137], v[130:131]
  v_pk_fma_f32 v[132:133], v[114:115], v[136:137], v[132:133]
  v_pk_fma_f32 v[118:119], v[102:103], v[134:135], v[118:119]
  v_pk_fma_f32 v[120:121], v[104:105], v[134:135], v[120:121]
  v_pk_fma_f32 v[122:123], v[106:107], v[134:135], v[122:123]
  v_pk_fma_f32 v[124:125], v[108:109], v[134:135], v[124:125]
  v_pk_fma_f32 v[126:127], v[110:111], v[134:135], v[126:127]
  v_pk_fma_f32 v[128:129], v[112:113], v[134:135], v[128:129]
  v_pk_fma_f32 v[130:131], v[114:115], v[134:135], v[130:131]
  v_pk_fma_f32 v[132:133], v[116:117], v[134:135], v[132:133]
  v_lshlrev_b32 v96, 16, v215
  v_and_b32 v97, 0xffff0000, v215
  v_lshlrev_b32 v98, 16, v216
  v_and_b32 v99, 0xffff0000, v216
  v_lshlrev_b32 v100, 16, v217
  v_and_b32 v101, 0xffff0000, v217
  v_lshlrev_b32 v102, 16, v218
  v_and_b32 v103, 0xffff0000, v218
  v_lshlrev_b32 v104, 16, v219
  v_and_b32 v105, 0xffff0000, v219
  v_lshlrev_b32 v106, 16, v220
  v_and_b32 v107, 0xffff0000, v220
  v_lshlrev_b32 v108, 16, v221
  v_and_b32 v109, 0xffff0000, v221
  v_lshlrev_b32 v110, 16, v222
  v_and_b32 v111, 0xffff0000, v222
  v_pk_mul_f32 v[118:119], v[118:119], v[96:97]
  v_pk_mul_f32 v[120:121], v[120:121], v[98:99]
  v_pk_mul_f32 v[122:123], v[122:123], v[100:101]
  v_pk_mul_f32 v[124:125], v[124:125], v[102:103]
  v_pk_mul_f32 v[126:127], v[126:127], v[104:105]
  v_pk_mul_f32 v[128:129], v[128:129], v[106:107]
  v_pk_mul_f32 v[130:131], v[130:131], v[108:109]
  v_pk_mul_f32 v[132:133], v[132:133], v[110:111]
  s_lshl_b32 s30, s2, 13
  s_lshl_b32 s31, s20, 11
  s_add_u32 s30, s30, s31
  s_add_u32 s30, s30, 10485760
  v_lshrrev_b32 v240, 3, v23
  v_and_b32 v241, 7, v23
  v_lshlrev_b32 v240, 8, v240
  v_lshl_add_u32 v240, v241, 4, v240
  v_cvt_pk_bf16_f32 v228, v132, v130
  v_cvt_pk_bf16_f32 v229, v128, v126
  v_cvt_pk_bf16_f32 v230, v124, v122
  v_cvt_pk_bf16_f32 v231, v120, v118
  buffer_store_dwordx4 v[228:231], v240, s[16:19], s30 offen offset:0 sc1
  v_cvt_pk_bf16_f32 v232, v133, v131
  v_cvt_pk_bf16_f32 v233, v129, v127
  v_cvt_pk_bf16_f32 v234, v125, v123
  v_cvt_pk_bf16_f32 v235, v121, v119
  buffer_store_dwordx4 v[232:235], v240, s[16:19], s30 offen offset:128 sc1
K_kc2_e:
  buffer_load_dwordx4 v[96:99], v27, s[40:43], 0 offen offset:0
  buffer_load_dwordx4 v[100:103], v27, s[40:43], 0 offen offset:4
  buffer_load_dwordx4 v[104:107], v27, s[40:43], 0 offen offset:8
  buffer_load_dwordx4 v[108:111], v27, s[40:43], 0 offen offset:12
  buffer_load_dwordx4 v[112:115], v28, s[40:43], 0 offen
  s_waitcnt vmcnt(0)
  s_barrier
  v_mov_b32 v21, s23
  v_mov_b32 v18, s68
  v_mov_b32 v19, s69
  s_mov_b64 exec, 1
  buffer_store_dwordx2 v[18:19], v21, s[16:19], 0 offen sc1
  s_mov_b64 exec, -1
  v_mov_b32 v132, 0
  v_mov_b32 v133, 0
  v_mov_b32 v134, 0
  v_mov_b32 v135, 0
  s_and_b32 s54, s20, 3
  v_and_b32 v19, 31, v23
  s_mul_i32 s30, s20, 1536
  s_add_u32 s30, s30, 66560
  v_lshl_add_u32 v19, v19, 4, s30
  ds_write_b128 v19, v[132:135]
  s_mul_i32 s49, s48, 81920
  s_add_u32 s49, s49, 32768
  v_and_b32 v21, 7, v23
  v_mul_u32_u24 v21, 4192, v21
  v_add_u32 v21, s49, v21
  v_lshrrev_b32 v19, 3, v23
  v_min_u32 v19, 2, v19
  v_lshl_add_u32 v19, v19, 4, v21
  ds_write_b128 v19, v[132:135]
  s_add_u32 s30, s49, 64
  v_add_u32 v18, s30, v26
  s_cmp_lg_u32 s54, 0
  s_cbranch_scc1 K_nofix2
  s_mov_b64 exec, 1
  v_mov_b32 v96, 0
  v_mov_b32 v97, 0
  v_mov_b32 v98, 0
  v_mov_b32 v99, 0
  v_mov_b32 v100, 0
  v_mov_b32 v101, 0
  v_mov_b32 v102, 0
  v_mov_b32 v103, v112
  v_mov_b32 v104, 0
  v_mov_b32 v105, 0
  v_mov_b32 v106, v112
  v_mov_b32 v107, v113
  v_mov_b32 v108, 0
  v_mov_b32 v109, v112
  v_mov_b32 v110, v113
  v_mov_b32 v111, v114
  s_mov_b64 exec, -1
K_nofix2:
  ds_write_b128 v18, v[100:103] offset:4192
  v_alignbit_b32 v116, v100, v96, 16
  v_alignbit_b32 v117, v101, v97, 16
  v_alignbit_b32 v118, v102, v98, 16
  v_alignbit_b32 v119, v103, v99, 16
  ds_write_b128 v18, v[116:119] offset:0
  ds_write_b128 v18, v[104:107] offset:12576
  v_alignbit_b32 v120, v104, v100, 16
  v_alignbit_b32 v121, v105, v101, 16
  v_alignbit_b32 v122, v106, v102, 16
  v_alignbit_b32 v123, v107, v103, 16
  ds_write_b128 v18, v[120:123] offset:8384
  ds_write_b128 v18, v[108:111] offset:20960
  v_alignbit_b32 v124, v108, v104, 16
  v_alignbit_b32 v125, v109, v105, 16
  v_alignbit_b32 v126, v110, v106, 16
  v_alignbit_b32 v127, v111, v107, 16
  ds_write_b128 v18, v[124:127] offset:16768
  ds_write_b128 v18, v[112:115] offset:29344
  v_alignbit_b32 v128, v112, v108, 16
  v_alignbit_b32 v129, v113, v109, 16
  v_alignbit_b32 v130, v114, v110, 16
  v_alignbit_b32 v131, v115, v111, 16
  ds_write_b128 v18, v[128:131] offset:25152
  s_cmp_lg_u32 s20, 0
  s_cbranch_scc1 K_pb2_x
  s_mov_b32 s62, 0x4000
K_pb2:
  s_sleep 3
  buffer_load_dwordx2 v[30:31], v242, s[16:19], 0 offen sc1
  s_sub_u32 s62, s62, 1
  s_waitcnt vmcnt(0)
K_pb2_c:
  v_cmp_ne_u64 vcc, s[68:69], v[30:31]
  s_cmp_eq_u32 s62, 0
  s_cbranch_scc1 K_pb2_y
  s_cmp_lg_u64 vcc, 0
  s_cbranch_scc1 K_pb2
K_pb2_y:
K_pb2_x:
  s_barrier
  v_lshrrev_b32 v29, 1, v23
  v_lshlrev_b32 v29, 16, v29
  v_and_b32 v30, 1, v23
  v_lshl_add_u32 v29, v30, 6, v29
  s_lshl_b32 s30, s36, 7
  s_and_b32 s31, s20, 3
  s_lshl_b32 s31, s31, 4
  s_add_u32 s30, s30, s31
  s_add_u32 s30, s30, 10485760
  s_mul_i32 s31, s20, 1536
  s_add_u32 m0, s31, 67072
  v_lshlrev_b32 v3, 4, v23
  buffer_load_dwordx4 v29, s[16:19], s30 offen lds
  s_mul_i32 s30, s20, 28672
  s_mul_i32 s32, s51, 229376
  s_add_u32 s32, s32, s30
  s_add_u32 s32, s32, 8388608
  s_mul_i32 s33, s50, 229376
  s_add_u32 s33, s33, s30
  s_lshr_b32 s30, s20, 1
  s_lshl_b32 s30, s30, 4
  v_and_b32 v24, 15, v23
  v_add_u32 v24, s30, v24
  s_and_b32 s30, s20, 1
  s_lshl_b32 s30, s30, 2
  v_lshrrev_b32 v25, 4, v23
  v_add_u32 v25, s30, v25
  v_lshlrev_b32 v8, 10, v24
  v_lshl_add_u32 v8, v25, 4, v8
  v_lshlrev_b32 v9, 3, v24
  s_lshl_b32 s21, s50, 16
  s_lshl_b32 s30, s51, 7
  s_add_u32 s21, s21, s30
  s_lshl_b32 s22, s50, 9
  s_add_u32 s22, s22, 14680064
  buffer_load_dwordx4 v[12:15], v8, s[4:7], s21 offen
  buffer_load_dwordx2 v[10:11], v9, s[16:19], s22 offen
  s_waitcnt vmcnt(0)
  buffer_load_dwordx4 v[144:147], v3, s[16:19], s32 offen offset:0
  buffer_load_dwordx4 v[148:151], v3, s[16:19], s32 offen offset:1024
  s_mov_b64 s[64:65], 0
  s_branch K_p2b
K_codeend:
.section .rodata,"a"
.p2align 6
.amdhsa_kernel fused_kernel
  .amdhsa_next_free_vgpr 256
  .amdhsa_next_free_sgpr 102
  .amdhsa_accum_offset 256
  .amdhsa_group_segment_fixed_size 0
  .amdhsa_kernarg_size 104
  .amdhsa_user_sgpr_count 2
  .amdhsa_user_sgpr_kernarg_segment_ptr 1
  .amdhsa_system_sgpr_workgroup_id_x 1
.end_amdhsa_kernel
```
